```python
import torch

def _softmax(x, axis=-1):
    return torch.softmax(x, dim=axis)
def _gelu(x):
    return torch.nn.functional.gelu(x, approximate="tanh")
def _silu(x):
    return torch.nn.functional.silu(x)
def _sigmoid(x):
    return torch.sigmoid(x)
def _layernorm(x, axis=-1, eps=1e-5):
    m = x.mean(dim=axis, keepdim=True)
    v = x.var(dim=axis, keepdim=True, unbiased=False)
    return (x - m) / torch.sqrt(v + eps)
def _scatter_add(tgt, idx, src, axis=0):
    return tgt.clone().index_add_(axis, idx, src)
def _segment_sum(src, seg, n):
    out = torch.zeros((n,) + src.shape[1:], dtype=src.dtype)
    return out.index_add_(0, seg, src)
def _pad(x, pw):
    flat = tuple(v for pair in reversed(pw) for v in pair)
    return torch.nn.functional.pad(x, flat)

kernel_name = 'sequential_preLN__spectral_fnet__glu_gated_glu__prompt'

def setup_inputs():

    _w = (lambda a: (lambda t: t.to(torch.bfloat16) if t.is_floating_point() else t)(torch.as_tensor(a)))
    def _A_setup():
        B, S, D = 1, 2048, 512
        ns = torch.arange(S)[:, None] * torch.arange(S)[None, :]
        nd = torch.arange(D)[:, None] * torch.arange(D)[None, :]
        Ws_re = torch.cos(-2.0 * torch.pi * ns / S).to(float)
        Ws_im = torch.sin(-2.0 * torch.pi * ns / S).to(float)
        Wd_re = torch.cos(-2.0 * torch.pi * nd / D).to(float)
        Wd_im = torch.sin(-2.0 * torch.pi * nd / D).to(float)
        return {
            "x": _w((lambda *s: torch.randn(*s, dtype=torch.bfloat16) * 0.05)(B, S, D)),
            "dft_seq_re": _w(Ws_re),
            "dft_seq_im": _w(Ws_im),
            "dft_hid_re": _w(Wd_re),
            "dft_hid_im": _w(Wd_im),
        }
    _A_in = _A_setup()

    def _B_setup():
        B, S, D, F = 1, 2048, 512, 1792
        return {
            "x": _w((lambda *s: torch.randn(*s, dtype=torch.bfloat16) * 0.05)(B, S, D)),
            "w_gate": _w((lambda *s: torch.randn(*s, dtype=torch.bfloat16) * 1.6)(D, F)),
            "w_up": _w((lambda *s: torch.randn(*s, dtype=torch.bfloat16) * 0.8)(D, F)),
            "w_down": _w((lambda *s: torch.randn(*s, dtype=torch.bfloat16) * 0.8)(F, D)),
        }
    _B_in = _B_setup()

    return {
        "A_x": _A_in["x"],
        "A_dft_seq_re": _A_in["dft_seq_re"],
        "A_dft_seq_im": _A_in["dft_seq_im"],
        "A_dft_hid_re": _A_in["dft_hid_re"],
        "A_dft_hid_im": _A_in["dft_hid_im"],
        "B_x": _B_in["x"],
        "B_w_gate": _B_in["w_gate"],
        "B_w_up": _B_in["w_up"],
        "B_w_down": _B_in["w_down"],
    }

def reference(A_x, A_dft_seq_re, A_dft_seq_im, A_dft_hid_re, A_dft_hid_im, B_x, B_w_gate, B_w_up, B_w_down):
    def _A_ref(x, dft_seq_re, dft_seq_im, dft_hid_re, dft_hid_im):
        a = torch.einsum("bsd,ed->bse", x, dft_hid_re)
        b = torch.einsum("bsd,ed->bse", x, dft_hid_im)
        y = torch.einsum("ts,bse->bte", dft_seq_re, a) - torch.einsum("ts,bse->bte", dft_seq_im, b)
        return y

    def _B_ref(x, w_gate, w_up, w_down):
        g = torch.einsum("bsd,df->bsf", x, w_gate)
        u = torch.einsum("bsd,df->bsf", x, w_up)
        h = _sigmoid(g) * u
        return torch.einsum("bsf,fd->bsd", h, w_down)

    x = A_x
    h = x + _A_ref(_layernorm(x, axis=-1), A_dft_seq_re, A_dft_seq_im, A_dft_hid_re, A_dft_hid_im)
    h2 = h + _B_ref(_layernorm(h, axis=-1), B_w_gate, B_w_up, B_w_down)
    return h2
```

```asm
; @launch kernel=k1_kernel grid=(256,1,1) block=(512,1,1) lds=163840
; @launch kernel=k2_kernel grid=(256,1,1) block=(256,1,1) lds=163840
.amdgcn_target "amdgcn-amd-amdhsa--gfx950"
.text
.globl k1_kernel
.p2align 8
.type k1_kernel,@function
k1_kernel:
  s_cmp_ge_u32 s2, 256
  s_cbranch_scc1 K1_done
  s_load_dwordx2 s[4:5], s[0:1], 0
  s_load_dwordx2 s[6:7], s[0:1], 88
  s_load_dwordx4 s[8:11], s[0:1], 48
  s_load_dwordx2 s[12:13], s[0:1], 64
  v_lshrrev_b32 v1, 6, v0
  v_and_b32 v2, 63, v0
  v_readfirstlane_b32 s14, v1
  v_and_b32 v3, 15, v2
  v_lshrrev_b32 v4, 4, v2
  v_lshlrev_b32 v13, 4, v2
  s_and_b32 s15, s2, 7
  s_lshl_b32 s15, s15, 1
  s_bfe_u32 s16, s2, 0x10003
  s_or_b32 s15, s15, s16
  s_lshr_b32 s16, s2, 4
  s_cmp_ge_u32 s14, 4
  s_cbranch_scc1 K1_helper
  v_lshrrev_b32 v5, 2, v2
  v_lshlrev_b32 v5, 17, v5
  s_lshl_b32 s17, s14, 15
  s_lshl_b32 s18, s15, 10
  s_add_u32 s18, s18, s17
  v_add_u32 v5, s18, v5
  v_sub_u32 v6, 0, v4
  v_xor_b32 v6, v6, v2
  v_and_b32 v6, 3, v6
  v_lshl_add_u32 v7, v6, 4, v5
  s_and_b32 s46, s16, 7
  s_add_u32 s47, s46, 0
  s_and_b32 s47, s47, 7
  s_lshl_b32 s47, s47, 6
  v_add_u32 v240, s47, v7
  s_add_u32 s47, s46, 1
  s_and_b32 s47, s47, 7
  s_lshl_b32 s47, s47, 6
  v_add_u32 v241, s47, v7
  s_add_u32 s47, s46, 2
  s_and_b32 s47, s47, 7
  s_lshl_b32 s47, s47, 6
  v_add_u32 v242, s47, v7
  s_add_u32 s47, s46, 3
  s_and_b32 s47, s47, 7
  s_lshl_b32 s47, s47, 6
  v_add_u32 v243, s47, v7
  s_add_u32 s47, s46, 4
  s_and_b32 s47, s47, 7
  s_lshl_b32 s47, s47, 6
  v_add_u32 v244, s47, v7
  s_add_u32 s47, s46, 5
  s_and_b32 s47, s47, 7
  s_lshl_b32 s47, s47, 6
  v_add_u32 v245, s47, v7
  s_add_u32 s47, s46, 6
  s_and_b32 s47, s47, 7
  s_lshl_b32 s47, s47, 6
  v_add_u32 v246, s47, v7
  s_add_u32 s47, s46, 7
  s_and_b32 s47, s47, 7
  s_lshl_b32 s47, s47, 6
  v_add_u32 v247, s47, v7
  s_waitcnt lgkmcnt(0)
  s_add_u32 s48, s4, 0x4000
  s_addc_u32 s49, s5, 0
  s_add_u32 m0, s17, 0
  s_nop 0
  global_load_lds_dwordx4 v240, s[4:5] offset:0
  s_add_u32 m0, s17, 16384
  s_nop 0
  global_load_lds_dwordx4 v240, s[48:49] offset:0
  s_add_u32 m0, s17, 7680
  s_nop 0
  global_load_lds_dwordx4 v240, s[4:5] offset:512
  s_add_u32 m0, s17, 24064
  s_nop 0
  global_load_lds_dwordx4 v240, s[48:49] offset:512
  s_add_u32 m0, s17, 1024
  s_nop 0
  global_load_lds_dwordx4 v241, s[4:5] offset:0
  s_add_u32 m0, s17, 17408
  s_nop 0
  global_load_lds_dwordx4 v241, s[48:49] offset:0
  s_add_u32 m0, s17, 8704
  s_nop 0
  global_load_lds_dwordx4 v241, s[4:5] offset:512
  s_add_u32 m0, s17, 25088
  s_nop 0
  global_load_lds_dwordx4 v241, s[48:49] offset:512
  s_add_u32 m0, s17, 2048
  s_nop 0
  global_load_lds_dwordx4 v242, s[4:5] offset:0
  s_mov_b32 s20, 0x41c80000
  s_lshl_b32 s21, s16, 4
  s_add_u32 s21, s21, 1
  v_add_u32 v9, s21, v3
  v_cvt_f32_u32 v10, v9
  v_mul_f32 v10, 0xbb000000, v10
  v_lshlrev_b32 v11, 31, v9
  v_or_b32 v56, 1.0, v11
  s_lshl_b32 s21, s14, 1
  s_add_u32 s21, s21, s46
  s_add_u32 s50, s21, 1
  s_and_b32 s21, s21, 7
  s_and_b32 s50, s50, 7
  s_add_u32 m0, s17, 18432
  s_nop 0
  global_load_lds_dwordx4 v242, s[48:49] offset:0
  s_lshl_b32 s21, s21, 5
  s_lshl_b32 s50, s50, 5
  v_lshlrev_b32 v12, 3, v4
  v_add_u32 v62, s50, v12
  v_add_u32 v12, s21, v12
  v_cvt_f32_u32 v12, v12
  v_cvt_f32_u32 v62, v62
  v_mul_f32 v12, v10, v12
  v_mul_f32 v62, v10, v62
  s_lshl_b32 s21, s14, 12
  s_add_u32 s21, s21, 131072
  v_add_u32 v14, s21, v13
  s_cmp_eq_u32 s16, 15
  s_cselect_b32 s22, 0x80008000, 0
  s_cselect_b32 s23, 0x80008000, 0
  s_cselect_b32 s18, 0x8000, 0
  s_cmp_eq_u32 s14, 0
  s_cselect_b32 s18, s18, 0
  s_mov_b32 s19, 0
  s_add_u32 m0, s17, 9728
  v_mov_b32 v15, 0x3f80
  global_load_lds_dwordx4 v242, s[4:5] offset:512
  v_cndmask_b32 v57, v56, 0, s[22:23]
  v_cndmask_b32 v58, 0, 1.0, s[22:23]
  v_cos_f32 v16, v12
  v_sin_f32 v24, v12
  v_add_f32 v12, v10, v12
  v_cos_f32 v17, v12
  v_sin_f32 v25, v12
  v_add_f32 v12, v10, v12
  v_cos_f32 v18, v12
  v_sin_f32 v26, v12
  v_add_f32 v12, v10, v12
  v_cos_f32 v19, v12
  s_add_u32 m0, s17, 26112
  v_sin_f32 v27, v12
  global_load_lds_dwordx4 v242, s[48:49] offset:512
  v_add_f32 v12, v10, v12
  v_cos_f32 v20, v12
  v_sin_f32 v28, v12
  v_add_f32 v12, v10, v12
  v_cos_f32 v21, v12
  v_sin_f32 v29, v12
  v_add_f32 v12, v10, v12
  v_cos_f32 v22, v12
  v_sin_f32 v30, v12
  v_add_f32 v12, v10, v12
  v_cos_f32 v23, v12
  v_sin_f32 v31, v12
  v_cvt_pk_bf16_f32 v32, v16, v17
  s_add_u32 m0, s17, 3072
  v_cvt_pk_bf16_f32 v36, v24, v25
  global_load_lds_dwordx4 v243, s[4:5] offset:0
  v_cvt_pk_bf16_f32 v33, v18, v19
  v_cvt_pk_bf16_f32 v37, v26, v27
  v_cvt_pk_bf16_f32 v34, v20, v21
  v_cvt_pk_bf16_f32 v38, v28, v29
  v_cvt_pk_bf16_f32 v35, v22, v23
  v_cvt_pk_bf16_f32 v39, v30, v31
  ds_write_b128 v14, v[32:35] offset:0
  ds_write_b128 v14, v[36:39] offset:1024
  v_mov_b32 v12, v62
  v_cos_f32 v16, v12
  v_sin_f32 v24, v12
  v_add_f32 v12, v10, v12
  v_cos_f32 v17, v12
  s_add_u32 m0, s17, 19456
  v_sin_f32 v25, v12
  global_load_lds_dwordx4 v243, s[48:49] offset:0
  v_add_f32 v12, v10, v12
  v_cos_f32 v18, v12
  v_sin_f32 v26, v12
  v_add_f32 v12, v10, v12
  v_cos_f32 v19, v12
  v_sin_f32 v27, v12
  v_add_f32 v12, v10, v12
  v_cos_f32 v20, v12
  v_sin_f32 v28, v12
  v_add_f32 v12, v10, v12
  v_cos_f32 v21, v12
  v_sin_f32 v29, v12
  s_add_u32 m0, s17, 10752
  v_add_f32 v12, v10, v12
  global_load_lds_dwordx4 v243, s[4:5] offset:512
  v_cos_f32 v22, v12
  v_sin_f32 v30, v12
  v_add_f32 v12, v10, v12
  v_cos_f32 v23, v12
  v_sin_f32 v31, v12
  v_cvt_pk_bf16_f32 v40, v16, v17
  v_cvt_pk_bf16_f32 v44, v24, v25
  v_cvt_pk_bf16_f32 v41, v18, v19
  v_cvt_pk_bf16_f32 v45, v26, v27
  v_cvt_pk_bf16_f32 v42, v20, v21
  v_cvt_pk_bf16_f32 v46, v28, v29
  v_cvt_pk_bf16_f32 v43, v22, v23
  v_cvt_pk_bf16_f32 v47, v30, v31
  s_add_u32 m0, s17, 27136
  v_cndmask_b32 v44, v44, v15, s[18:19]
  global_load_lds_dwordx4 v243, s[48:49] offset:512
  ds_write_b128 v14, v[40:43] offset:2048
  ds_write_b128 v14, v[44:47] offset:3072
  v_lshrrev_b32 v5, 2, v3
  v_sub_u32 v5, 0, v5
  v_and_b32 v5, 3, v5
  v_xor_b32 v6, v5, v4
  v_lshlrev_b32 v6, 4, v6
  v_lshl_add_u32 v6, v3, 6, v6
  v_add_u32 v6, s17, v6
  v_add_u32 v61, 131072, v13
  v_mov_b32 v224, 0x3f803f80
  v_mov_b32 v225, 0x3f803f80
  v_mov_b32 v226, 0x3f803f80
  v_mov_b32 v227, 0x3f803f80
  s_waitcnt lgkmcnt(0)
  s_barrier
  s_add_u32 m0, s17, 4096
  s_nop 0
  global_load_lds_dwordx4 v244, s[4:5] offset:0
  s_add_u32 m0, s17, 20480
  s_nop 0
  global_load_lds_dwordx4 v244, s[48:49] offset:0
  s_add_u32 m0, s17, 11776
  s_nop 0
  global_load_lds_dwordx4 v244, s[4:5] offset:512
  s_add_u32 m0, s17, 28160
  s_nop 0
  global_load_lds_dwordx4 v244, s[48:49] offset:512
  s_waitcnt vmcnt(16)
  ds_read_b128 v[160:163], v61 offset:0
  ds_read_b128 v[164:167], v61 offset:1024
  ds_read_b128 v[168:171], v6 offset:0
  ds_read_b128 v[172:175], v6 offset:16384
  ds_read_b128 v[176:179], v6 offset:8192
  ds_read_b128 v[180:183], v6 offset:24576
  s_waitcnt vmcnt(12)
  ds_read_b128 v[184:187], v61 offset:2048
  ds_read_b128 v[188:191], v61 offset:3072
  ds_read_b128 v[192:195], v6 offset:1024
  ds_read_b128 v[196:199], v6 offset:17408
  ds_read_b128 v[200:203], v6 offset:9216
  ds_read_b128 v[204:207], v6 offset:25600
  s_waitcnt lgkmcnt(6)
  v_lshlrev_b32 v59, 16, v168
  v_lshlrev_b32 v60, 16, v172
  s_add_u32 m0, s17, 5120
  v_mfma_f32_16x16x32_bf16 v[216:219], v[168:171], v[168:171], 0
  global_load_lds_dwordx4 v245, s[4:5] offset:0
  s_lshl_b32 s21, s14, 4
  v_mfma_f32_16x16x32_bf16 v[208:211], v[168:171], v[224:227], 0
  v_add_u32 v9, s21, v3
  v_cvt_f32_u32 v10, v9
  v_mfma_f32_16x16x32_bf16 v[220:223], v[172:175], v[172:175], 0
  v_mul_f32 v10, 0x3c000000, v10
  v_mul_f32 v11, 0x41000000, v10
  v_lshlrev_b32 v12, 5, v4
  v_mfma_f32_16x16x32_bf16 v[212:215], v[172:175], v[224:227], 0
  v_cvt_f32_u32 v12, v12
  s_add_u32 m0, s17, 21504
  v_mfma_f32_16x16x32_bf16 v[216:219], v[176:179], v[176:179], v[216:219]
  global_load_lds_dwordx4 v245, s[48:49] offset:0
  v_mul_f32 v12, v10, v12
  v_mov_b32 v15, 0x80008000
  v_mfma_f32_16x16x32_bf16 v[208:211], v[176:179], v[224:227], v[208:211]
  v_mov_b32 v14, v12
  v_cos_f32 v16, v14
  v_mfma_f32_16x16x32_bf16 v[220:223], v[180:183], v[180:183], v[220:223]
  v_sin_f32 v24, v14
  v_add_f32 v14, v11, v14
  v_cos_f32 v17, v14
  v_mfma_f32_16x16x32_bf16 v[212:215], v[180:183], v[224:227], v[212:215]
  v_sin_f32 v25, v14
  s_add_u32 m0, s17, 12800
  v_mfma_f32_16x16x32_bf16 v[128:131], v[168:171], v[160:163], 0
  global_load_lds_dwordx4 v245, s[4:5] offset:512
  v_add_f32 v14, v11, v14
  v_mfma_f32_16x16x32_bf16 v[132:135], v[168:171], v[164:167], 0
  v_cos_f32 v18, v14
  v_sin_f32 v26, v14
  v_add_f32 v14, v11, v14
  v_mfma_f32_16x16x32_bf16 v[136:139], v[172:175], v[160:163], 0
  v_cos_f32 v19, v14
  v_sin_f32 v27, v14
  v_mfma_f32_16x16x32_bf16 v[140:143], v[172:175], v[164:167], 0
  v_add_f32 v12, v10, v12
  v_mov_b32 v14, v12
  s_add_u32 m0, s17, 29184
  v_mfma_f32_16x16x32_bf16 v[144:147], v[176:179], v[160:163], 0
  global_load_lds_dwordx4 v245, s[48:49] offset:512
  v_cos_f32 v20, v14
  v_mfma_f32_16x16x32_bf16 v[148:151], v[176:179], v[164:167], 0
  v_sin_f32 v28, v14
  v_add_f32 v14, v11, v14
  v_cos_f32 v21, v14
  v_mfma_f32_16x16x32_bf16 v[152:155], v[180:183], v[160:163], 0
  v_sin_f32 v29, v14
  v_add_f32 v14, v11, v14
  v_mfma_f32_16x16x32_bf16 v[156:159], v[180:183], v[164:167], 0
  v_cos_f32 v22, v14
  v_sin_f32 v30, v14
  s_waitcnt vmcnt(12)
  ds_read_b128 v[160:163], v61 offset:4096
  ds_read_b128 v[164:167], v61 offset:5120
  ds_read_b128 v[168:171], v6 offset:2048
  ds_read_b128 v[172:175], v6 offset:18432
  ds_read_b128 v[176:179], v6 offset:10240
  ds_read_b128 v[180:183], v6 offset:26624
  s_waitcnt lgkmcnt(6)
  s_add_u32 m0, s17, 6144
  v_mfma_f32_16x16x32_bf16 v[216:219], v[192:195], v[192:195], v[216:219]
  global_load_lds_dwordx4 v246, s[4:5] offset:0
  v_add_f32 v14, v11, v14
  v_mfma_f32_16x16x32_bf16 v[208:211], v[192:195], v[224:227], v[208:211]
  v_cos_f32 v23, v14
  v_sin_f32 v31, v14
  v_mfma_f32_16x16x32_bf16 v[220:223], v[196:199], v[196:199], v[220:223]
  v_add_f32 v12, v10, v12
  v_cvt_pk_bf16_f32 v64, v16, v17
  v_cvt_pk_bf16_f32 v80, v24, v25
  v_mfma_f32_16x16x32_bf16 v[212:215], v[196:199], v[224:227], v[212:215]
  v_cvt_pk_bf16_f32 v65, v18, v19
  s_add_u32 m0, s17, 22528
  v_mfma_f32_16x16x32_bf16 v[216:219], v[200:203], v[200:203], v[216:219]
  global_load_lds_dwordx4 v246, s[48:49] offset:0
  v_cvt_pk_bf16_f32 v81, v26, v27
  v_cvt_pk_bf16_f32 v66, v20, v21
  v_mfma_f32_16x16x32_bf16 v[208:211], v[200:203], v[224:227], v[208:211]
  v_cvt_pk_bf16_f32 v82, v28, v29
  v_cvt_pk_bf16_f32 v67, v22, v23
  v_mfma_f32_16x16x32_bf16 v[220:223], v[204:207], v[204:207], v[220:223]
  v_cvt_pk_bf16_f32 v83, v30, v31
  v_mov_b32 v96, v64
  v_xor_b32 v98, v15, v66
  v_mfma_f32_16x16x32_bf16 v[212:215], v[204:207], v[224:227], v[212:215]
  v_mov_b32 v97, v65
  s_add_u32 m0, s17, 13824
  v_mfma_f32_16x16x32_bf16 v[128:131], v[192:195], v[184:187], v[128:131]
  global_load_lds_dwordx4 v246, s[4:5] offset:512
  v_xor_b32 v99, v15, v67
  v_mfma_f32_16x16x32_bf16 v[132:135], v[192:195], v[188:191], v[132:135]
  v_mov_b32 v112, v80
  v_xor_b32 v114, v15, v82
  v_mov_b32 v113, v81
  v_mfma_f32_16x16x32_bf16 v[136:139], v[196:199], v[184:187], v[136:139]
  v_xor_b32 v115, v15, v83
  v_mov_b32 v14, v12
  v_mfma_f32_16x16x32_bf16 v[140:143], v[196:199], v[188:191], v[140:143]
  v_cos_f32 v16, v14
  v_sin_f32 v24, v14
  s_add_u32 m0, s17, 30208
  v_mfma_f32_16x16x32_bf16 v[144:147], v[200:203], v[184:187], v[144:147]
  global_load_lds_dwordx4 v246, s[48:49] offset:512
  v_add_f32 v14, v11, v14
  v_mfma_f32_16x16x32_bf16 v[148:151], v[200:203], v[188:191], v[148:151]
  v_cos_f32 v17, v14
  v_sin_f32 v25, v14
  v_add_f32 v14, v11, v14
  v_mfma_f32_16x16x32_bf16 v[152:155], v[204:207], v[184:187], v[152:155]
  v_cos_f32 v18, v14
  v_sin_f32 v26, v14
  v_mfma_f32_16x16x32_bf16 v[156:159], v[204:207], v[188:191], v[156:159]
  v_add_f32 v14, v11, v14
  v_cos_f32 v19, v14
  s_waitcnt vmcnt(12)
  ds_read_b128 v[184:187], v61 offset:6144
  ds_read_b128 v[188:191], v61 offset:7168
  ds_read_b128 v[192:195], v6 offset:3072
  ds_read_b128 v[196:199], v6 offset:19456
  ds_read_b128 v[200:203], v6 offset:11264
  ds_read_b128 v[204:207], v6 offset:27648
  s_waitcnt lgkmcnt(6)
  s_add_u32 m0, s17, 7168
  v_mfma_f32_16x16x32_bf16 v[216:219], v[168:171], v[168:171], v[216:219]
  global_load_lds_dwordx4 v247, s[4:5] offset:0
  v_sin_f32 v27, v14
  v_mfma_f32_16x16x32_bf16 v[208:211], v[168:171], v[224:227], v[208:211]
  v_add_f32 v12, v10, v12
  v_mov_b32 v14, v12
  v_mfma_f32_16x16x32_bf16 v[220:223], v[172:175], v[172:175], v[220:223]
  v_cos_f32 v20, v14
  v_sin_f32 v28, v14
  v_add_f32 v14, v11, v14
  v_mfma_f32_16x16x32_bf16 v[212:215], v[172:175], v[224:227], v[212:215]
  v_cos_f32 v21, v14
  s_add_u32 m0, s17, 23552
  v_mfma_f32_16x16x32_bf16 v[216:219], v[176:179], v[176:179], v[216:219]
  global_load_lds_dwordx4 v247, s[48:49] offset:0
  v_sin_f32 v29, v14
  v_add_f32 v14, v11, v14
  v_mfma_f32_16x16x32_bf16 v[208:211], v[176:179], v[224:227], v[208:211]
  v_cos_f32 v22, v14
  v_sin_f32 v30, v14
  v_mfma_f32_16x16x32_bf16 v[220:223], v[180:183], v[180:183], v[220:223]
  v_add_f32 v14, v11, v14
  v_cos_f32 v23, v14
  v_sin_f32 v31, v14
  v_mfma_f32_16x16x32_bf16 v[212:215], v[180:183], v[224:227], v[212:215]
  v_add_f32 v12, v10, v12
  s_add_u32 m0, s17, 14848
  v_mfma_f32_16x16x32_bf16 v[128:131], v[168:171], v[160:163], v[128:131]
  global_load_lds_dwordx4 v247, s[4:5] offset:512
  v_cvt_pk_bf16_f32 v68, v16, v17
  v_mfma_f32_16x16x32_bf16 v[132:135], v[168:171], v[164:167], v[132:135]
  v_cvt_pk_bf16_f32 v84, v24, v25
  v_cvt_pk_bf16_f32 v69, v18, v19
  v_cvt_pk_bf16_f32 v85, v26, v27
  v_mfma_f32_16x16x32_bf16 v[136:139], v[172:175], v[160:163], v[136:139]
  v_cvt_pk_bf16_f32 v70, v20, v21
  v_cvt_pk_bf16_f32 v86, v28, v29
  v_mfma_f32_16x16x32_bf16 v[140:143], v[172:175], v[164:167], v[140:143]
  v_cvt_pk_bf16_f32 v71, v22, v23
  v_cvt_pk_bf16_f32 v87, v30, v31
  s_add_u32 m0, s17, 31232
  v_mfma_f32_16x16x32_bf16 v[144:147], v[176:179], v[160:163], v[144:147]
  global_load_lds_dwordx4 v247, s[48:49] offset:512
  v_mov_b32 v100, v68
  v_mfma_f32_16x16x32_bf16 v[148:151], v[176:179], v[164:167], v[148:151]
  v_xor_b32 v102, v15, v70
  v_mov_b32 v101, v69
  v_xor_b32 v103, v15, v71
  v_mfma_f32_16x16x32_bf16 v[152:155], v[180:183], v[160:163], v[152:155]
  v_mov_b32 v116, v84
  v_xor_b32 v118, v15, v86
  v_mfma_f32_16x16x32_bf16 v[156:159], v[180:183], v[164:167], v[156:159]
  v_mov_b32 v117, v85
  v_xor_b32 v119, v15, v87
  s_waitcnt vmcnt(12)
  ds_read_b128 v[160:163], v61 offset:8192
  ds_read_b128 v[164:167], v61 offset:9216
  ds_read_b128 v[168:171], v6 offset:4096
  ds_read_b128 v[172:175], v6 offset:20480
  ds_read_b128 v[176:179], v6 offset:12288
  ds_read_b128 v[180:183], v6 offset:28672
  s_waitcnt lgkmcnt(6)
  v_mfma_f32_16x16x32_bf16 v[216:219], v[192:195], v[192:195], v[216:219]
  v_mov_b32 v14, v12
  v_cos_f32 v16, v14
  v_mfma_f32_16x16x32_bf16 v[208:211], v[192:195], v[224:227], v[208:211]
  v_sin_f32 v24, v14
  v_add_f32 v14, v11, v14
  v_mfma_f32_16x16x32_bf16 v[220:223], v[196:199], v[196:199], v[220:223]
  v_cos_f32 v17, v14
  v_sin_f32 v25, v14
  v_mfma_f32_16x16x32_bf16 v[212:215], v[196:199], v[224:227], v[212:215]
  v_add_f32 v14, v11, v14
  v_cos_f32 v18, v14
  v_mfma_f32_16x16x32_bf16 v[216:219], v[200:203], v[200:203], v[216:219]
  v_sin_f32 v26, v14
  v_add_f32 v14, v11, v14
  v_mfma_f32_16x16x32_bf16 v[208:211], v[200:203], v[224:227], v[208:211]
  v_cos_f32 v19, v14
  v_sin_f32 v27, v14
  v_mfma_f32_16x16x32_bf16 v[220:223], v[204:207], v[204:207], v[220:223]
  v_add_f32 v12, v10, v12
  v_mov_b32 v14, v12
  v_mfma_f32_16x16x32_bf16 v[212:215], v[204:207], v[224:227], v[212:215]
  v_cos_f32 v20, v14
  v_sin_f32 v28, v14
  v_mfma_f32_16x16x32_bf16 v[128:131], v[192:195], v[184:187], v[128:131]
  v_add_f32 v14, v11, v14
  v_cos_f32 v21, v14
  v_mfma_f32_16x16x32_bf16 v[132:135], v[192:195], v[188:191], v[132:135]
  v_sin_f32 v29, v14
  v_add_f32 v14, v11, v14
  v_mfma_f32_16x16x32_bf16 v[136:139], v[196:199], v[184:187], v[136:139]
  v_cos_f32 v22, v14
  v_sin_f32 v30, v14
  v_mfma_f32_16x16x32_bf16 v[140:143], v[196:199], v[188:191], v[140:143]
  v_add_f32 v14, v11, v14
  v_cos_f32 v23, v14
  v_mfma_f32_16x16x32_bf16 v[144:147], v[200:203], v[184:187], v[144:147]
  v_sin_f32 v31, v14
  v_add_f32 v12, v10, v12
  v_mfma_f32_16x16x32_bf16 v[148:151], v[200:203], v[188:191], v[148:151]
  v_cvt_pk_bf16_f32 v72, v16, v17
  v_cvt_pk_bf16_f32 v88, v24, v25
  v_mfma_f32_16x16x32_bf16 v[152:155], v[204:207], v[184:187], v[152:155]
  v_cvt_pk_bf16_f32 v73, v18, v19
  v_cvt_pk_bf16_f32 v89, v26, v27
  v_mfma_f32_16x16x32_bf16 v[156:159], v[204:207], v[188:191], v[156:159]
  v_cvt_pk_bf16_f32 v74, v20, v21
  s_waitcnt vmcnt(8)
  ds_read_b128 v[184:187], v61 offset:10240
  ds_read_b128 v[188:191], v61 offset:11264
  ds_read_b128 v[192:195], v6 offset:5120
  ds_read_b128 v[196:199], v6 offset:21504
  ds_read_b128 v[200:203], v6 offset:13312
  ds_read_b128 v[204:207], v6 offset:29696
  s_waitcnt lgkmcnt(6)
  v_mfma_f32_16x16x32_bf16 v[216:219], v[168:171], v[168:171], v[216:219]
  v_cvt_pk_bf16_f32 v90, v28, v29
  v_cvt_pk_bf16_f32 v75, v22, v23
  v_mfma_f32_16x16x32_bf16 v[208:211], v[168:171], v[224:227], v[208:211]
  v_cvt_pk_bf16_f32 v91, v30, v31
  v_mov_b32 v104, v72
  v_mfma_f32_16x16x32_bf16 v[220:223], v[172:175], v[172:175], v[220:223]
  v_xor_b32 v106, v15, v74
  v_mov_b32 v105, v73
  v_mfma_f32_16x16x32_bf16 v[212:215], v[172:175], v[224:227], v[212:215]
  v_xor_b32 v107, v15, v75
  v_mov_b32 v120, v88
  v_mfma_f32_16x16x32_bf16 v[216:219], v[176:179], v[176:179], v[216:219]
  v_xor_b32 v122, v15, v90
  v_mov_b32 v121, v89
  v_mfma_f32_16x16x32_bf16 v[208:211], v[176:179], v[224:227], v[208:211]
  v_xor_b32 v123, v15, v91
  v_mov_b32 v14, v12
  v_mfma_f32_16x16x32_bf16 v[220:223], v[180:183], v[180:183], v[220:223]
  v_cos_f32 v16, v14
  v_sin_f32 v24, v14
  v_mfma_f32_16x16x32_bf16 v[212:215], v[180:183], v[224:227], v[212:215]
  v_add_f32 v14, v11, v14
  v_cos_f32 v17, v14
  v_mfma_f32_16x16x32_bf16 v[128:131], v[168:171], v[160:163], v[128:131]
  v_sin_f32 v25, v14
  v_add_f32 v14, v11, v14
  v_mfma_f32_16x16x32_bf16 v[132:135], v[168:171], v[164:167], v[132:135]
  v_cos_f32 v18, v14
  v_sin_f32 v26, v14
  v_mfma_f32_16x16x32_bf16 v[136:139], v[172:175], v[160:163], v[136:139]
  v_add_f32 v14, v11, v14
  v_cos_f32 v19, v14
  v_mfma_f32_16x16x32_bf16 v[140:143], v[172:175], v[164:167], v[140:143]
  v_sin_f32 v27, v14
  v_add_f32 v12, v10, v12
  v_mfma_f32_16x16x32_bf16 v[144:147], v[176:179], v[160:163], v[144:147]
  v_mov_b32 v14, v12
  v_cos_f32 v20, v14
  v_mfma_f32_16x16x32_bf16 v[148:151], v[176:179], v[164:167], v[148:151]
  v_sin_f32 v28, v14
  v_add_f32 v14, v11, v14
  v_mfma_f32_16x16x32_bf16 v[152:155], v[180:183], v[160:163], v[152:155]
  v_cos_f32 v21, v14
  v_sin_f32 v29, v14
  v_mfma_f32_16x16x32_bf16 v[156:159], v[180:183], v[164:167], v[156:159]
  v_add_f32 v14, v11, v14
  s_waitcnt vmcnt(4)
  ds_read_b128 v[160:163], v61 offset:12288
  ds_read_b128 v[164:167], v61 offset:13312
  ds_read_b128 v[168:171], v6 offset:6144
  ds_read_b128 v[172:175], v6 offset:22528
  ds_read_b128 v[176:179], v6 offset:14336
  ds_read_b128 v[180:183], v6 offset:30720
  s_waitcnt lgkmcnt(6)
  v_mfma_f32_16x16x32_bf16 v[216:219], v[192:195], v[192:195], v[216:219]
  v_cos_f32 v22, v14
  v_sin_f32 v30, v14
  v_mfma_f32_16x16x32_bf16 v[208:211], v[192:195], v[224:227], v[208:211]
  v_add_f32 v14, v11, v14
  v_cos_f32 v23, v14
  v_mfma_f32_16x16x32_bf16 v[220:223], v[196:199], v[196:199], v[220:223]
  v_sin_f32 v31, v14
  v_add_f32 v12, v10, v12
  v_mfma_f32_16x16x32_bf16 v[212:215], v[196:199], v[224:227], v[212:215]
  v_cvt_pk_bf16_f32 v76, v16, v17
  v_cvt_pk_bf16_f32 v92, v24, v25
  v_mfma_f32_16x16x32_bf16 v[216:219], v[200:203], v[200:203], v[216:219]
  v_cvt_pk_bf16_f32 v77, v18, v19
  v_cvt_pk_bf16_f32 v93, v26, v27
  v_mfma_f32_16x16x32_bf16 v[208:211], v[200:203], v[224:227], v[208:211]
  v_cvt_pk_bf16_f32 v78, v20, v21
  v_cvt_pk_bf16_f32 v94, v28, v29
  v_mfma_f32_16x16x32_bf16 v[220:223], v[204:207], v[204:207], v[220:223]
  v_cvt_pk_bf16_f32 v79, v22, v23
  v_cvt_pk_bf16_f32 v95, v30, v31
  v_mfma_f32_16x16x32_bf16 v[212:215], v[204:207], v[224:227], v[212:215]
  v_mov_b32 v108, v76
  v_xor_b32 v110, v15, v78
  v_mfma_f32_16x16x32_bf16 v[128:131], v[192:195], v[184:187], v[128:131]
  v_mov_b32 v109, v77
  v_xor_b32 v111, v15, v79
  v_mfma_f32_16x16x32_bf16 v[132:135], v[192:195], v[188:191], v[132:135]
  v_mov_b32 v124, v92
  v_xor_b32 v126, v15, v94
  v_mfma_f32_16x16x32_bf16 v[136:139], v[196:199], v[184:187], v[136:139]
  v_mov_b32 v125, v93
  v_xor_b32 v127, v15, v95
  v_mfma_f32_16x16x32_bf16 v[140:143], v[196:199], v[188:191], v[140:143]
  v_mul_u32_u24 v16, 80, v4
  s_sub_u32 s21, 23, s16
  s_cmp_lt_u32 s16, 8
  s_cselect_b32 s21, s16, s21
  s_cselect_b32 s24, 16, 0
  s_add_u32 s50, s21, 1
  s_and_b32 s50, s50, 15
  s_sub_u32 s51, s21, s46
  s_and_b32 s51, s51, 7
  s_and_b32 s21, s21, 8
  s_add_u32 s21, s21, s51
  s_lshl_b32 s21, s21, 10
  s_sub_u32 s51, s50, s46
  s_and_b32 s51, s51, 7
  s_and_b32 s50, s50, 8
  s_add_u32 s50, s50, s51
  s_lshl_b32 s50, s50, 10
  s_mov_b32 s52, 0
  s_mov_b32 s53, 0xffff0000
  v_mfma_f32_16x16x32_bf16 v[144:147], v[200:203], v[184:187], v[144:147]
  v_add_u32 v25, s21, v6
  v_add_u32 v26, 1, v4
  v_mfma_f32_16x16x32_bf16 v[148:151], v[200:203], v[188:191], v[148:151]
  v_and_b32 v26, 3, v26
  v_xor_b32 v26, v26, v5
  v_mfma_f32_16x16x32_bf16 v[152:155], v[204:207], v[184:187], v[152:155]
  v_lshlrev_b32 v26, 4, v26
  v_lshl_add_u32 v26, v3, 6, v26
  v_mfma_f32_16x16x32_bf16 v[156:159], v[204:207], v[188:191], v[156:159]
  v_mov_b32 v27, s21
  s_waitcnt vmcnt(0)
  ds_read_b128 v[184:187], v61 offset:14336
  ds_read_b128 v[188:191], v61 offset:15360
  ds_read_b128 v[192:195], v6 offset:7168
  ds_read_b128 v[196:199], v6 offset:23552
  ds_read_b128 v[200:203], v6 offset:15360
  ds_read_b128 v[204:207], v6 offset:31744
  s_waitcnt lgkmcnt(6)
  v_mfma_f32_16x16x32_bf16 v[216:219], v[168:171], v[168:171], v[216:219]
  v_mov_b32 v28, s50
  v_cndmask_b32 v27, v27, v28, s[52:53]
  v_mfma_f32_16x16x32_bf16 v[208:211], v[168:171], v[224:227], v[208:211]
  v_add3_u32 v26, v26, v27, s17
  s_lshl_b32 s21, s14, 5
  v_mfma_f32_16x16x32_bf16 v[220:223], v[172:175], v[172:175], v[220:223]
  s_add_u32 s21, s21, s15
  v_mfma_f32_16x16x32_bf16 v[212:215], v[172:175], v[224:227], v[212:215]
  s_lshl_b32 s26, s21, 14
  s_lshl_b32 s27, s46, 11
  v_mfma_f32_16x16x32_bf16 v[216:219], v[176:179], v[176:179], v[216:219]
  s_add_u32 s26, s26, s27
  s_lshr_b32 s27, s16, 3
  v_mfma_f32_16x16x32_bf16 v[208:211], v[176:179], v[224:227], v[208:211]
  s_lshl_b32 s27, s27, 10
  v_mfma_f32_16x16x32_bf16 v[220:223], v[180:183], v[180:183], v[220:223]
  s_add_u32 s26, s26, s27
  s_add_u32 s26, s26, 3145728
  v_mfma_f32_16x16x32_bf16 v[212:215], v[180:183], v[224:227], v[212:215]
  v_add_u32 v28, s26, v13
  v_mfma_f32_16x16x32_bf16 v[128:131], v[168:171], v[160:163], v[128:131]
  v_add_u32 v29, 0x40000, v28
  v_mov_b32 v30, s24
  v_mfma_f32_16x16x32_bf16 v[132:135], v[168:171], v[164:167], v[132:135]
  v_lshlrev_b32 v31, 14, v9
  s_lshl_b32 s26, s16, 10
  v_mfma_f32_16x16x32_bf16 v[136:139], v[172:175], v[160:163], v[136:139]
  s_lshl_b32 s27, s15, 6
  v_mfma_f32_16x16x32_bf16 v[140:143], v[172:175], v[164:167], v[140:143]
  s_add_u32 s26, s26, s27
  v_add_u32 v31, s26, v31
  v_mfma_f32_16x16x32_bf16 v[144:147], v[176:179], v[160:163], v[144:147]
  v_lshl_add_u32 v31, v4, 4, v31
  v_add_u32 v17, 0x100000, v31
  v_mfma_f32_16x16x32_bf16 v[148:151], v[176:179], v[164:167], v[148:151]
  v_add_u32 v18, s17, v13
  v_mfma_f32_16x16x32_bf16 v[152:155], v[180:183], v[160:163], v[152:155]
  v_add_u32 v19, 0x10000, v13
  s_mov_b32 s25, 0x3b000000
  v_mfma_f32_16x16x32_bf16 v[156:159], v[180:183], v[164:167], v[156:159]
  v_mov_b32 v27, 0x3727c5ac
  ds_read_b128 v[32:35], v25
  ds_read_b32 v36, v26
  ds_read_b128 v[40:43], v25 offset:16384
  ds_read_b32 v44, v26 offset:16384
  s_waitcnt lgkmcnt(4)
  v_mfma_f32_16x16x32_bf16 v[216:219], v[192:195], v[192:195], v[216:219]
  v_mfma_f32_16x16x32_bf16 v[208:211], v[192:195], v[224:227], v[208:211]
  v_mfma_f32_16x16x32_bf16 v[220:223], v[196:199], v[196:199], v[220:223]
  v_mfma_f32_16x16x32_bf16 v[212:215], v[196:199], v[224:227], v[212:215]
  v_mfma_f32_16x16x32_bf16 v[216:219], v[200:203], v[200:203], v[216:219]
  v_mfma_f32_16x16x32_bf16 v[208:211], v[200:203], v[224:227], v[208:211]
  v_mfma_f32_16x16x32_bf16 v[220:223], v[204:207], v[204:207], v[220:223]
  v_mfma_f32_16x16x32_bf16 v[212:215], v[204:207], v[224:227], v[212:215]
  v_mfma_f32_16x16x32_bf16 v[128:131], v[192:195], v[184:187], v[128:131]
  v_mfma_f32_16x16x32_bf16 v[132:135], v[192:195], v[188:191], v[132:135]
  v_mfma_f32_16x16x32_bf16 v[136:139], v[196:199], v[184:187], v[136:139]
  v_mfma_f32_16x16x32_bf16 v[140:143], v[196:199], v[188:191], v[140:143]
  v_mfma_f32_16x16x32_bf16 v[144:147], v[200:203], v[184:187], v[144:147]
  v_mfma_f32_16x16x32_bf16 v[148:151], v[200:203], v[188:191], v[148:151]
  v_mfma_f32_16x16x32_bf16 v[152:155], v[204:207], v[184:187], v[152:155]
  v_mfma_f32_16x16x32_bf16 v[156:159], v[204:207], v[188:191], v[156:159]
  ds_bpermute_b32 v160, v16, v216 offset:0
  ds_bpermute_b32 v161, v16, v217 offset:4
  ds_bpermute_b32 v162, v16, v218 offset:8
  ds_bpermute_b32 v163, v16, v219 offset:12
  ds_bpermute_b32 v164, v16, v220 offset:0
  ds_bpermute_b32 v165, v16, v221 offset:4
  ds_bpermute_b32 v166, v16, v222 offset:8
  ds_bpermute_b32 v167, v16, v223 offset:12
  s_waitcnt lgkmcnt(8)
  v_alignbit_b32 v48, v33, v32, v30
  v_alignbit_b32 v49, v34, v33, v30
  v_alignbit_b32 v50, v35, v34, v30
  v_alignbit_b32 v51, v36, v35, v30
  global_store_dwordx4 v28, v[48:51], s[6:7]
  v_alignbit_b32 v52, v41, v40, v30
  v_alignbit_b32 v53, v42, v41, v30
  v_alignbit_b32 v54, v43, v42, v30
  v_alignbit_b32 v55, v44, v43, v30
  global_store_dwordx4 v29, v[52:55], s[6:7]
  v_mul_f32 v208, s25, v208
  v_mul_f32 v209, s25, v209
  v_mul_f32 v210, s25, v210
  v_mul_f32 v211, s25, v211
  v_mul_f32 v212, s25, v212
  v_mul_f32 v213, s25, v213
  v_mul_f32 v214, s25, v214
  v_mul_f32 v215, s25, v215
  v_fma_f32 v128, v144, v56, v128
  v_fma_f32 v129, v145, v56, v129
  v_fma_f32 v130, v146, v56, v130
  v_fma_f32 v131, v147, v56, v131
  v_fma_f32 v132, v148, v57, v132
  v_fma_f32 v133, v149, v57, v133
  v_fma_f32 v134, v150, v57, v134
  v_fma_f32 v135, v151, v57, v135
  v_fma_f32 v136, v152, v56, v136
  v_fma_f32 v137, v153, v56, v137
  v_fma_f32 v138, v154, v56, v138
  v_fma_f32 v139, v155, v56, v139
  v_fma_f32 v140, v156, v57, v140
  v_fma_f32 v141, v157, v57, v141
  v_fma_f32 v142, v158, v57, v142
  v_fma_f32 v143, v159, v57, v143
  v_fma_f32 v132, -v208, v58, v132
  v_fma_f32 v133, -v209, v58, v133
  v_fma_f32 v134, -v210, v58, v134
  v_fma_f32 v135, -v211, v58, v135
  v_fma_f32 v140, -v212, v58, v140
  v_fma_f32 v141, -v213, v58, v141
  v_fma_f32 v142, -v214, v58, v142
  v_fma_f32 v143, -v215, v58, v143
  s_waitcnt lgkmcnt(0)
  v_fma_f32 v160, v160, s25, v27
  v_fma_f32 v160, -v208, v208, v160
  v_rsq_f32 v160, v160
  v_fma_f32 v161, v161, s25, v27
  v_fma_f32 v161, -v209, v209, v161
  v_rsq_f32 v161, v161
  v_fma_f32 v162, v162, s25, v27
  v_fma_f32 v162, -v210, v210, v162
  v_rsq_f32 v162, v162
  v_fma_f32 v163, v163, s25, v27
  v_fma_f32 v163, -v211, v211, v163
  v_rsq_f32 v163, v163
  v_fma_f32 v164, v164, s25, v27
  v_fma_f32 v164, -v212, v212, v164
  v_rsq_f32 v164, v164
  v_fma_f32 v165, v165, s25, v27
  v_fma_f32 v165, -v213, v213, v165
  v_rsq_f32 v165, v165
  v_fma_f32 v166, v166, s25, v27
  v_fma_f32 v166, -v214, v214, v166
  v_rsq_f32 v166, v166
  v_fma_f32 v167, v167, s25, v27
  v_fma_f32 v167, -v215, v215, v167
  v_rsq_f32 v167, v167
  v_mul_f32 v128, v128, v160
  v_mul_f32 v129, v129, v161
  v_mul_f32 v130, v130, v162
  v_mul_f32 v131, v131, v163
  v_mul_f32 v132, v132, v160
  v_mul_f32 v133, v133, v161
  v_mul_f32 v134, v134, v162
  v_mul_f32 v135, v135, v163
  v_mul_f32 v136, v136, v164
  v_mul_f32 v137, v137, v165
  v_mul_f32 v138, v138, v166
  v_mul_f32 v139, v139, v167
  v_mul_f32 v140, v140, v164
  v_mul_f32 v141, v141, v165
  v_mul_f32 v142, v142, v166
  v_mul_f32 v143, v143, v167
  v_cvt_pk_bf16_f32 v184, v128, v129
  v_cvt_pk_bf16_f32 v185, v130, v131
  v_cvt_pk_bf16_f32 v186, v136, v137
  v_cvt_pk_bf16_f32 v187, v138, v139
  v_cvt_pk_bf16_f32 v188, v132, v133
  v_cvt_pk_bf16_f32 v189, v134, v135
  v_cvt_pk_bf16_f32 v190, v140, v141
  v_cvt_pk_bf16_f32 v191, v142, v143
  ds_write_b128 v18, v[184:187]
  ds_write_b128 v18, v[188:191] offset:1024
  s_cmp_lg_u32 s16, 0
  s_cbranch_scc1 K1_nomx
  s_lshl_b32 s26, s21, 6
  s_add_u32 s26, s26, 2097152
  v_lshl_add_u32 v20, v4, 4, s26
  v_lshl_add_u32 v21, v3, 2, s26
  s_mov_b64 s[28:29], exec
  s_mov_b32 exec_lo, 0x00010001
  s_mov_b32 exec_hi, 0x00010001
  global_store_dwordx4 v20, v[208:211], s[6:7]
  global_store_dwordx4 v20, v[212:215], s[6:7] offset:1024
  s_mov_b64 exec, 0xffff
  v_add_u32 v21, 8192, v21
  global_store_dword v21, v59, s[6:7]
  global_store_dword v21, v60, s[6:7] offset:1024
  s_mov_b64 exec, s[28:29]
K1_nomx:
  s_waitcnt lgkmcnt(0)
  s_barrier
  ds_read_b128 v[192:195], v13 offset:0
  ds_read_b128 v[160:163], v13 offset:1024
  ds_read_b128 v[196:199], v13 offset:32768
  ds_read_b128 v[164:167], v13 offset:33792
  ds_read_b128 v[200:203], v19 offset:0
  ds_read_b128 v[168:171], v19 offset:1024
  ds_read_b128 v[204:207], v19 offset:32768
  ds_read_b128 v[172:175], v19 offset:33792
  s_waitcnt lgkmcnt(6)
  v_xor_b32 v232, v15, v192
  v_xor_b32 v233, v15, v193
  v_xor_b32 v234, v15, v194
  v_xor_b32 v235, v15, v195
  v_mfma_f32_16x16x32_bf16 v[128:131], v[192:195], v[64:67], 0
  v_mfma_f32_16x16x32_bf16 v[132:135], v[160:163], v[64:67], 0
  v_mfma_f32_16x16x32_bf16 v[136:139], v[192:195], v[96:99], 0
  v_mfma_f32_16x16x32_bf16 v[140:143], v[160:163], v[96:99], 0
  v_mfma_f32_16x16x32_bf16 v[128:131], v[160:163], v[80:83], v[128:131]
  v_mfma_f32_16x16x32_bf16 v[132:135], v[232:235], v[80:83], v[132:135]
  v_mfma_f32_16x16x32_bf16 v[136:139], v[160:163], v[112:115], v[136:139]
  v_mfma_f32_16x16x32_bf16 v[140:143], v[232:235], v[112:115], v[140:143]
  s_waitcnt lgkmcnt(4)
  v_xor_b32 v236, v15, v196
  v_xor_b32 v237, v15, v197
  v_xor_b32 v238, v15, v198
  v_xor_b32 v239, v15, v199
  v_mfma_f32_16x16x32_bf16 v[128:131], v[196:199], v[68:71], v[128:131]
  v_mfma_f32_16x16x32_bf16 v[132:135], v[164:167], v[68:71], v[132:135]
  v_mfma_f32_16x16x32_bf16 v[136:139], v[196:199], v[100:103], v[136:139]
  v_mfma_f32_16x16x32_bf16 v[140:143], v[164:167], v[100:103], v[140:143]
  v_mfma_f32_16x16x32_bf16 v[128:131], v[164:167], v[84:87], v[128:131]
  v_mfma_f32_16x16x32_bf16 v[132:135], v[236:239], v[84:87], v[132:135]
  v_mfma_f32_16x16x32_bf16 v[136:139], v[164:167], v[116:119], v[136:139]
  v_mfma_f32_16x16x32_bf16 v[140:143], v[236:239], v[116:119], v[140:143]
  s_waitcnt lgkmcnt(2)
  v_xor_b32 v240, v15, v200
  v_xor_b32 v241, v15, v201
  v_xor_b32 v242, v15, v202
  v_xor_b32 v243, v15, v203
  v_mfma_f32_16x16x32_bf16 v[128:131], v[200:203], v[72:75], v[128:131]
  v_mfma_f32_16x16x32_bf16 v[132:135], v[168:171], v[72:75], v[132:135]
  v_mfma_f32_16x16x32_bf16 v[136:139], v[200:203], v[104:107], v[136:139]
  v_mfma_f32_16x16x32_bf16 v[140:143], v[168:171], v[104:107], v[140:143]
  v_mfma_f32_16x16x32_bf16 v[128:131], v[168:171], v[88:91], v[128:131]
  v_mfma_f32_16x16x32_bf16 v[132:135], v[240:243], v[88:91], v[132:135]
  v_mfma_f32_16x16x32_bf16 v[136:139], v[168:171], v[120:123], v[136:139]
  v_mfma_f32_16x16x32_bf16 v[140:143], v[240:243], v[120:123], v[140:143]
  s_waitcnt lgkmcnt(0)
  v_xor_b32 v244, v15, v204
  v_xor_b32 v245, v15, v205
  v_xor_b32 v246, v15, v206
  v_xor_b32 v247, v15, v207
  v_mfma_f32_16x16x32_bf16 v[128:131], v[204:207], v[76:79], v[128:131]
  v_mfma_f32_16x16x32_bf16 v[132:135], v[172:175], v[76:79], v[132:135]
  v_mfma_f32_16x16x32_bf16 v[136:139], v[204:207], v[108:111], v[136:139]
  v_mfma_f32_16x16x32_bf16 v[140:143], v[172:175], v[108:111], v[140:143]
  v_mfma_f32_16x16x32_bf16 v[128:131], v[172:175], v[92:95], v[128:131]
  v_mfma_f32_16x16x32_bf16 v[132:135], v[244:247], v[92:95], v[132:135]
  v_mfma_f32_16x16x32_bf16 v[136:139], v[172:175], v[124:127], v[136:139]
  v_mfma_f32_16x16x32_bf16 v[140:143], v[244:247], v[124:127], v[140:143]
  s_nop 4
  v_cvt_pk_bf16_f32 v32, v128, v129
  v_cvt_pk_bf16_f32 v33, v130, v131
  v_cvt_pk_bf16_f32 v34, v132, v133
  v_cvt_pk_bf16_f32 v35, v134, v135
  global_store_dwordx4 v31, v[32:35], s[6:7]
  v_cvt_pk_bf16_f32 v36, v136, v137
  v_cvt_pk_bf16_f32 v37, v138, v139
  v_cvt_pk_bf16_f32 v38, v140, v141
  v_cvt_pk_bf16_f32 v39, v142, v143
  global_store_dwordx4 v17, v[36:39], s[6:7]
  s_endpgm
K1_helper:
  s_mov_b32 s45, s14
  s_barrier
  s_sub_u32 s14, s14, 4
  s_lshl_b32 s17, s2, 2
  s_add_u32 s17, s17, s14
  s_lshl_b32 s24, s14, 12
  s_add_u32 s24, s24, 147456
  v_add_u32 v14, s24, v13
  v_lshrrev_b32 v5, 2, v3
  v_and_b32 v6, 3, v3
  v_lshlrev_b32 v6, 3, v6
  v_lshrrev_b32 v7, 1, v4
  v_lshl_add_u32 v7, v7, 3, v5
  v_lshl_add_u32 v7, v7, 6, v6
  v_and_b32 v8, 1, v4
  v_lshl_add_u32 v7, v8, 11, v7
  v_add_u32 v7, s24, v7
  v_lshrrev_b32 v9, 1, v4
  v_lshlrev_b32 v9, 4, v9
  v_lshl_add_u32 v9, v8, 2, v9
  v_add_u32 v9, v9, v5
  v_lshl_add_u32 v9, v9, 7, v6
  v_add_u32 v9, s24, v9
  v_lshrrev_b32 v10, 3, v2
  v_and_b32 v11, 7, v2
  v_lshlrev_b32 v11, 4, v11
  v_lshl_add_u32 v10, v10, 10, v11
  s_waitcnt lgkmcnt(0)
  s_cmp_ge_u32 s17, 16
  s_cbranch_scc1 K1_nofl
  s_lshl_b32 s26, s17, 10
  s_add_u32 s26, s26, 2228224
  v_add_u32 v12, s26, v13
  v_mov_b32 v16, 0
  v_mov_b32 v17, 0
  v_mov_b32 v18, 0
  v_mov_b32 v19, 0
  global_store_dwordx4 v12, v[16:19], s[6:7]
  s_nop 1
K1_nofl:
  s_sub_u32 s26, s17, 16
  s_cmp_ge_u32 s26, 21
  s_cbranch_scc1 K1_nopf
  s_getpc_b64 s[28:29]
K1_pc:
  s_add_u32 s28, s28, k2_kernel-K1_pc
  s_addc_u32 s29, s29, 0
  s_lshl_b32 s26, s26, 10
  v_add_u32 v12, s26, v13
  global_load_dwordx4 v[60:63], v12, s[28:29]
K1_nopf:
  s_cmp_ge_u32 s17, 896
  s_cbranch_scc1 K1_hA_down
  s_and_b32 s26, s17, 15
  s_lshr_b32 s27, s17, 4
  s_and_b32 s28, s26, 7
  s_lshl_b32 s28, s28, 5
  s_add_u32 s29, s28, 1
  s_sub_u32 s28, 511, s28
  s_cmp_lt_u32 s26, 8
  s_cselect_b32 s30, s29, s28
  s_cselect_b32 s31, 1, -1
  s_cselect_b32 s32, -1, 256
  s_lshl_b32 s33, s27, 6
  s_mov_b32 s34, 3584
  s_lshl_b32 s28, s27, 5
  s_add_u32 s28, s28, s26
  s_lshl_b32 s28, s28, 11
  s_add_u32 s40, s28, 8388608
  v_lshrrev_b32 v11, 2, v2
  v_and_b32 v15, 3, v2
  v_lshlrev_b32 v15, 4, v15
  v_add_u32 v12, 0, v11
  v_mul_lo_u32 v12, v12, s31
  v_add_u32 v12, s30, v12
  v_cmp_ne_u32 vcc, s32, v12
  s_nop 1
  v_cndmask_b32 v12, 0, v12, vcc
  v_mul_lo_u32 v12, v12, s34
  v_add3_u32 v12, v12, s33, v15
  global_load_dwordx4 v[16:19], v12, s[8:9]
  global_load_dwordx4 v[24:27], v12, s[10:11]
  v_add_u32 v12, 16, v11
  v_mul_lo_u32 v12, v12, s31
  v_add_u32 v12, s30, v12
  v_cmp_ne_u32 vcc, s32, v12
  s_nop 1
  v_cndmask_b32 v12, 0, v12, vcc
  v_mul_lo_u32 v12, v12, s34
  v_add3_u32 v12, v12, s33, v15
  global_load_dwordx4 v[20:23], v12, s[8:9]
  global_load_dwordx4 v[28:31], v12, s[10:11]
  s_branch K1_hA_go
K1_hA_down:
  s_sub_u32 s25, s17, 896
  s_lshr_b32 s26, s25, 3
  s_and_b32 s27, s25, 7
  s_and_b32 s28, s26, 15
  s_mul_i32 s28, s28, 7
  s_lshr_b32 s29, s26, 4
  s_lshl_b32 s29, s29, 1
  s_add_u32 s28, s28, s29
  s_sub_u32 s29, s26, 48
  s_mul_i32 s29, s29, 14
  s_add_u32 s29, s29, 6
  s_cmp_lt_u32 s26, 48
  s_cselect_b32 s28, s28, s29
  s_cselect_b32 s29, 1, 7
  s_lshl_b32 s28, s28, 14
  s_lshl_b32 s29, s29, 14
  s_sub_u32 s29, s29, 0x2000
  s_lshl_b32 s35, s27, 7
  s_add_u32 s28, s28, s35
  v_add_u32 v12, s28, v10
  s_mul_i32 s28, s27, 224
  s_add_u32 s28, s28, s26
  s_lshl_b32 s28, s28, 10
  s_add_u32 s40, s28, 12582912
  global_load_dwordx4 v[16:19], v12, s[12:13]
  v_add_u32 v12, 0x2000, v12
  global_load_dwordx4 v[20:23], v12, s[12:13]
  v_add_u32 v12, s29, v12
  global_load_dwordx4 v[24:27], v12, s[12:13]
  v_add_u32 v12, 0x2000, v12
  global_load_dwordx4 v[28:31], v12, s[12:13]
K1_hA_go:
  s_mul_i32 s44, s17, 5
  s_and_b32 s44, s44, 15
  s_cmp_ge_u32 s44, 5
  s_cbranch_scc1 K1_hB_skip
  s_lshr_b32 s25, s17, 4
  s_mul_i32 s25, s25, 5
  s_add_u32 s25, s25, s44
  s_add_u32 s25, s25, 128
  s_lshr_b32 s26, s25, 3
  s_and_b32 s27, s25, 7
  s_and_b32 s28, s26, 15
  s_mul_i32 s28, s28, 7
  s_lshr_b32 s29, s26, 4
  s_lshl_b32 s29, s29, 1
  s_add_u32 s28, s28, s29
  s_sub_u32 s29, s26, 48
  s_mul_i32 s29, s29, 14
  s_add_u32 s29, s29, 6
  s_cmp_lt_u32 s26, 48
  s_cselect_b32 s28, s28, s29
  s_cselect_b32 s29, 1, 7
  s_lshl_b32 s28, s28, 14
  s_lshl_b32 s29, s29, 14
  s_sub_u32 s29, s29, 0x2000
  s_lshl_b32 s35, s27, 7
  s_add_u32 s28, s28, s35
  v_add_u32 v12, s28, v10
  s_mul_i32 s28, s27, 224
  s_add_u32 s28, s28, s26
  s_lshl_b32 s28, s28, 10
  s_add_u32 s41, s28, 12582912
  global_load_dwordx4 v[32:35], v12, s[12:13]
  v_add_u32 v12, 0x2000, v12
  global_load_dwordx4 v[36:39], v12, s[12:13]
  v_add_u32 v12, s29, v12
  global_load_dwordx4 v[40:43], v12, s[12:13]
  v_add_u32 v12, 0x2000, v12
  global_load_dwordx4 v[44:47], v12, s[12:13]
K1_hB_skip:
  s_waitcnt vmcnt(0)
  s_cmp_ge_u32 s17, 896
  s_cbranch_scc1 K1_hA_down2
  ds_write_b128 v14, v[16:19] offset:0
  ds_write_b128 v14, v[20:23] offset:1024
  ds_write_b128 v14, v[24:27] offset:2048
  ds_write_b128 v14, v[28:31] offset:3072
  v_add_u32 v12, s40, v13
  s_waitcnt lgkmcnt(0)
  ds_read_b64_tr_b16 v[48:49], v7 offset:0
  ds_read_b64_tr_b16 v[50:51], v7 offset:1024
  ds_read_b64_tr_b16 v[52:53], v7 offset:256
  ds_read_b64_tr_b16 v[54:55], v7 offset:1280
  ds_read_b64_tr_b16 v[56:57], v7 offset:32
  ds_read_b64_tr_b16 v[58:59], v7 offset:1056
  ds_read_b64_tr_b16 v[60:61], v7 offset:288
  ds_read_b64_tr_b16 v[62:63], v7 offset:1312
  s_waitcnt lgkmcnt(6)
  global_store_dwordx4 v12, v[48:51], s[6:7] offset:0
  s_waitcnt lgkmcnt(4)
  global_store_dwordx4 v12, v[52:55], s[6:7] offset:1024
  v_add_u32 v12, 0x8000, v12
  s_waitcnt lgkmcnt(2)
  global_store_dwordx4 v12, v[56:59], s[6:7] offset:0
  s_waitcnt lgkmcnt(0)
  global_store_dwordx4 v12, v[60:63], s[6:7] offset:1024
  s_branch K1_hA_go2
K1_hA_down2:
  ds_write_b128 v14, v[16:19] offset:0
  ds_write_b128 v14, v[20:23] offset:1024
  ds_write_b128 v14, v[24:27] offset:2048
  ds_write_b128 v14, v[28:31] offset:3072
  v_add_u32 v12, s40, v13
  s_waitcnt lgkmcnt(0)
  ds_read_b64_tr_b16 v[48:49], v9 offset:0
  ds_read_b64_tr_b16 v[50:51], v9 offset:1024
  ds_read_b64_tr_b16 v[52:53], v9 offset:32
  ds_read_b64_tr_b16 v[54:55], v9 offset:1056
  ds_read_b64_tr_b16 v[56:57], v9 offset:64
  ds_read_b64_tr_b16 v[58:59], v9 offset:1088
  ds_read_b64_tr_b16 v[60:61], v9 offset:96
  ds_read_b64_tr_b16 v[62:63], v9 offset:1120
  s_waitcnt lgkmcnt(6)
  global_store_dwordx4 v12, v[48:51], s[6:7]
  v_add_u32 v12, 57344, v12
  s_waitcnt lgkmcnt(4)
  global_store_dwordx4 v12, v[52:55], s[6:7]
  v_add_u32 v12, 57344, v12
  s_waitcnt lgkmcnt(2)
  global_store_dwordx4 v12, v[56:59], s[6:7]
  v_add_u32 v12, 57344, v12
  s_waitcnt lgkmcnt(0)
  global_store_dwordx4 v12, v[60:63], s[6:7]
K1_hA_go2:
  s_cmp_ge_u32 s44, 5
  s_cbranch_scc1 K1_hend
  s_nop 1
  ds_write_b128 v14, v[32:35] offset:0
  ds_write_b128 v14, v[36:39] offset:1024
  ds_write_b128 v14, v[40:43] offset:2048
  ds_write_b128 v14, v[44:47] offset:3072
  v_add_u32 v12, s41, v13
  s_waitcnt lgkmcnt(0)
  ds_read_b64_tr_b16 v[48:49], v9 offset:0
  ds_read_b64_tr_b16 v[50:51], v9 offset:1024
  ds_read_b64_tr_b16 v[52:53], v9 offset:32
  ds_read_b64_tr_b16 v[54:55], v9 offset:1056
  ds_read_b64_tr_b16 v[56:57], v9 offset:64
  ds_read_b64_tr_b16 v[58:59], v9 offset:1088
  ds_read_b64_tr_b16 v[60:61], v9 offset:96
  ds_read_b64_tr_b16 v[62:63], v9 offset:1120
  s_waitcnt lgkmcnt(6)
  global_store_dwordx4 v12, v[48:51], s[6:7]
  v_add_u32 v12, 57344, v12
  s_waitcnt lgkmcnt(4)
  global_store_dwordx4 v12, v[52:55], s[6:7]
  v_add_u32 v12, 57344, v12
  s_waitcnt lgkmcnt(2)
  global_store_dwordx4 v12, v[56:59], s[6:7]
  v_add_u32 v12, 57344, v12
  s_waitcnt lgkmcnt(0)
  global_store_dwordx4 v12, v[60:63], s[6:7]
K1_hend:
K1_done:
  s_endpgm
.globl k2_kernel
.p2align 8
.type k2_kernel,@function
k2_kernel:
  s_cmp_ge_u32 s2, 256
  s_cbranch_scc1 K2_done
  s_load_dwordx2 s[6:7], s[0:1], 88
  s_load_dwordx4 s[8:11], s[0:1], 72
  v_lshrrev_b32 v1, 6, v0
  v_and_b32 v2, 63, v0
  v_readfirstlane_b32 s14, v1
  v_and_b32 v3, 15, v2
  v_lshrrev_b32 v4, 4, v2
  v_lshlrev_b32 v5, 4, v2
  s_and_b32 s15, s2, 3
  s_lshl_b32 s15, s15, 2
  s_bfe_u32 s16, s2, 0x20003
  s_add_u32 s15, s15, s16
  s_bfe_u32 s16, s2, 0x10002
  s_lshl_b32 s16, s16, 3
  s_lshr_b32 s17, s2, 5
  s_add_u32 s16, s16, s17
  s_lshl_b32 s17, s15, 2
  s_add_u32 s17, s17, s14
  s_sub_u32 s18, 128, s17
  s_cmp_eq_u32 s17, 0
  s_cselect_b32 s18, 64, s18
  s_cselect_b32 s19, 0, 16384
  s_cselect_b32 s20, 16384, 0
  s_mul_i32 s21, s14, 40960
  s_lshl_b32 s22, s17, 14
  s_lshl_b32 s23, s18, 14
  v_add_u32 v6, s22, v5
  v_add_u32 v7, s23, v5
  v_add_u32 v12, 3145728, v6
  v_add_u32 v13, 3145728, v7
  s_lshl_b32 s22, s17, 6
  s_lshl_b32 s23, s18, 6
  s_add_u32 s22, s22, 2097152
  s_add_u32 s23, s23, 2097152
  v_lshl_add_u32 v14, v3, 2, s22
  v_lshl_add_u32 v15, v3, 2, s23
  s_cmp_ge_u32 s16, 7
  s_cselect_b32 s53, 7, 0
  s_sub_u32 s53, s16, s53
  s_cmp_ge_u32 s53, 7
  s_cselect_b32 s22, 7, 0
  s_sub_u32 s53, s53, s22
  s_cmp_ge_u32 s15, 7
  s_cselect_b32 s54, 7, 0
  s_sub_u32 s54, s15, s54
  s_cmp_ge_u32 s54, 7
  s_cselect_b32 s22, 7, 0
  s_sub_u32 s54, s54, s22
  s_mov_b32 s53, 0
  s_mov_b32 s54, 0
  s_add_u32 s46, s53, 0
  s_cmp_ge_u32 s46, 7
  s_cselect_b32 s22, 7, 0
  s_sub_u32 s46, s46, s22
  s_lshl_b32 s46, s46, 11
  s_add_u32 s47, s53, 1
  s_cmp_ge_u32 s47, 7
  s_cselect_b32 s22, 7, 0
  s_sub_u32 s47, s47, s22
  s_lshl_b32 s47, s47, 11
  s_add_u32 s48, s53, 2
  s_cmp_ge_u32 s48, 7
  s_cselect_b32 s22, 7, 0
  s_sub_u32 s48, s48, s22
  s_lshl_b32 s48, s48, 11
  s_add_u32 s49, s53, 3
  s_cmp_ge_u32 s49, 7
  s_cselect_b32 s22, 7, 0
  s_sub_u32 s49, s49, s22
  s_lshl_b32 s49, s49, 11
  s_add_u32 s50, s53, 4
  s_cmp_ge_u32 s50, 7
  s_cselect_b32 s22, 7, 0
  s_sub_u32 s50, s50, s22
  s_lshl_b32 s50, s50, 11
  s_add_u32 s51, s53, 5
  s_cmp_ge_u32 s51, 7
  s_cselect_b32 s22, 7, 0
  s_sub_u32 s51, s51, s22
  s_lshl_b32 s51, s51, 11
  s_add_u32 s52, s53, 6
  s_cmp_ge_u32 s52, 7
  s_cselect_b32 s22, 7, 0
  s_sub_u32 s52, s52, s22
  s_lshl_b32 s52, s52, 11
  s_waitcnt lgkmcnt(0)
  s_add_u32 s26, s6, 8192
  s_addc_u32 s27, s7, 0
  s_add_u32 s28, s6, 12288
  s_addc_u32 s29, s7, 0
  s_add_u32 m0, s21, 12288
  s_nop 0
  global_load_lds_dwordx4 v6, s[28:29] offset:3072
  s_add_u32 m0, s21, 28672
  s_nop 0
  global_load_lds_dwordx4 v7, s[28:29] offset:3072
  global_load_dword v16, v14, s[6:7]
  global_load_dword v18, v15, s[6:7]
  global_load_dword v17, v14, s[26:27]
  global_load_dword v19, v15, s[26:27]
  s_add_u32 m0, s21, 0
  v_add_u32 v252, s46, v6
  global_load_lds_dwordx4 v252, s[6:7] offset:0
  s_add_u32 m0, s21, 0
  s_nop 0
  global_load_lds_dwordx4 v252, s[6:7] offset:1024
  s_add_u32 m0, s21, 16384
  v_add_u32 v253, s46, v7
  global_load_lds_dwordx4 v253, s[6:7] offset:0
  s_add_u32 m0, s21, 16384
  s_nop 0
  global_load_lds_dwordx4 v253, s[6:7] offset:1024
  v_add_u32 v254, s46, v12
  global_load_dwordx4 a[0:3], v254, s[6:7] offset:0
  global_load_dwordx4 a[32:35], v254, s[6:7] offset:1024
  v_add_u32 v255, s46, v13
  global_load_dwordx4 a[64:67], v255, s[6:7] offset:0
  global_load_dwordx4 a[96:99], v255, s[6:7] offset:1024
  s_add_u32 m0, s21, 2048
  v_add_u32 v252, s47, v6
  global_load_lds_dwordx4 v252, s[6:7] offset:0
  v_mov_b32 v127, 0x3f80
  v_lshlrev_b32 v8, 7, v3
  v_add_u32 v9, s18, v8
  v_add_u32 v8, s17, v8
  s_mov_b32 s32, 0xffff0000
  s_mov_b32 s33, 0xffff0000
  s_add_u32 m0, s21, 2048
  v_lshlrev_b32 v25, 2, v4
  global_load_lds_dwordx4 v252, s[6:7] offset:1024
  v_cvt_f32_u32 v25, v25
  v_mov_b32 v26, 0x80008000
  v_cvt_f32_u32 v27, v8
  v_mul_f32 v27, 0x3a000000, v27
  v_mul_f32 v28, v27, v25
  v_cos_f32 v72, v28
  v_sin_f32 v76, v28
  v_add_f32 v28, v27, v28
  s_add_u32 m0, s21, 18432
  v_add_u32 v253, s47, v7
  global_load_lds_dwordx4 v253, s[6:7] offset:0
  v_cos_f32 v73, v28
  v_sin_f32 v77, v28
  v_add_f32 v28, v27, v28
  v_cos_f32 v74, v28
  v_sin_f32 v78, v28
  v_add_f32 v28, v27, v28
  v_cos_f32 v75, v28
  s_add_u32 m0, s21, 18432
  v_sin_f32 v79, v28
  global_load_lds_dwordx4 v253, s[6:7] offset:1024
  v_mul_f32 v80, 0.5, v72
  v_mul_f32 v81, 0.5, v73
  v_mul_f32 v82, 0.5, v74
  v_mul_f32 v83, 0.5, v75
  v_mul_f32 v84, 0.5, v76
  v_mul_f32 v85, 0.5, v77
  v_mul_f32 v86, 0.5, v78
  v_mul_f32 v87, 0.5, v79
  v_add_u32 v254, s47, v12
  global_load_dwordx4 a[4:7], v254, s[6:7] offset:0
  v_cvt_pk_bf16_f32 v88, v72, v73
  v_cvt_pk_bf16_f32 v89, v74, v75
  v_cvt_pk_bf16_f32 v90, v76, v77
  v_cvt_pk_bf16_f32 v91, v78, v79
  v_cvt_pk_bf16_f32 v92, v80, v81
  v_cvt_pk_bf16_f32 v93, v82, v83
  v_cvt_pk_bf16_f32 v94, v84, v85
  global_load_dwordx4 a[36:39], v254, s[6:7] offset:1024
  v_cvt_pk_bf16_f32 v95, v86, v87
  v_xor_b32 v96, v26, v90
  v_xor_b32 v97, v26, v91
  v_xor_b32 v98, v26, v94
  v_xor_b32 v99, v26, v95
  v_cndmask_b32 v104, v98, v92, s[32:33]
  v_cndmask_b32 v106, v92, v98, s[32:33]
  v_cndmask_b32 v105, v99, v93, s[32:33]
  v_add_u32 v255, s47, v13
  global_load_dwordx4 a[68:71], v255, s[6:7] offset:0
  v_cndmask_b32 v107, v93, v99, s[32:33]
  v_cndmask_b32 v108, v94, v92, s[32:33]
  v_cndmask_b32 v110, v92, v94, s[32:33]
  v_cndmask_b32 v109, v95, v93, s[32:33]
  v_cndmask_b32 v111, v93, v95, s[32:33]
  v_cndmask_b32 v32, v88, v90, s[32:33]
  v_cndmask_b32 v34, v90, v88, s[32:33]
  v_cndmask_b32 v33, v89, v91, s[32:33]
  global_load_dwordx4 a[100:103], v255, s[6:7] offset:1024
  v_cndmask_b32 v35, v91, v89, s[32:33]
  v_cndmask_b32 v36, v88, v96, s[32:33]
  v_cndmask_b32 v38, v96, v88, s[32:33]
  v_cndmask_b32 v37, v89, v97, s[32:33]
  v_cndmask_b32 v39, v97, v89, s[32:33]
  v_cvt_f32_u32 v27, v9
  v_mul_f32 v27, 0x3a000000, v27
  v_mul_f32 v28, v27, v25
  s_add_u32 m0, s21, 4096
  v_add_u32 v252, s48, v6
  global_load_lds_dwordx4 v252, s[6:7] offset:0
  v_cos_f32 v72, v28
  v_sin_f32 v76, v28
  v_add_f32 v28, v27, v28
  v_cos_f32 v73, v28
  v_sin_f32 v77, v28
  v_add_f32 v28, v27, v28
  s_add_u32 m0, s21, 4096
  v_cos_f32 v74, v28
  global_load_lds_dwordx4 v252, s[6:7] offset:1024
  v_sin_f32 v78, v28
  v_add_f32 v28, v27, v28
  v_cos_f32 v75, v28
  v_sin_f32 v79, v28
  v_mul_f32 v80, 0.5, v72
  v_mul_f32 v81, 0.5, v73
  v_mul_f32 v82, 0.5, v74
  v_mul_f32 v83, 0.5, v75
  s_add_u32 m0, s21, 20480
  v_add_u32 v253, s48, v7
  global_load_lds_dwordx4 v253, s[6:7] offset:0
  v_mul_f32 v84, 0.5, v76
  v_mul_f32 v85, 0.5, v77
  v_mul_f32 v86, 0.5, v78
  v_mul_f32 v87, 0.5, v79
  v_cvt_pk_bf16_f32 v88, v72, v73
  v_cvt_pk_bf16_f32 v89, v74, v75
  v_cvt_pk_bf16_f32 v90, v76, v77
  s_add_u32 m0, s21, 20480
  v_cvt_pk_bf16_f32 v91, v78, v79
  global_load_lds_dwordx4 v253, s[6:7] offset:1024
  v_cvt_pk_bf16_f32 v92, v80, v81
  v_cvt_pk_bf16_f32 v93, v82, v83
  v_cvt_pk_bf16_f32 v94, v84, v85
  v_cvt_pk_bf16_f32 v95, v86, v87
  v_xor_b32 v96, v26, v90
  v_xor_b32 v97, v26, v91
  v_xor_b32 v98, v26, v94
  v_xor_b32 v99, v26, v95
  v_add_u32 v254, s48, v12
  global_load_dwordx4 a[8:11], v254, s[6:7] offset:0
  v_cndmask_b32 v112, v98, v92, s[32:33]
  v_cndmask_b32 v114, v92, v98, s[32:33]
  v_cndmask_b32 v113, v99, v93, s[32:33]
  v_cndmask_b32 v115, v93, v99, s[32:33]
  v_cndmask_b32 v116, v94, v92, s[32:33]
  v_cndmask_b32 v118, v92, v94, s[32:33]
  v_cndmask_b32 v117, v95, v93, s[32:33]
  global_load_dwordx4 a[40:43], v254, s[6:7] offset:1024
  v_cndmask_b32 v119, v93, v95, s[32:33]
  v_cndmask_b32 v40, v88, v90, s[32:33]
  v_cndmask_b32 v42, v90, v88, s[32:33]
  v_cndmask_b32 v41, v89, v91, s[32:33]
  v_cndmask_b32 v43, v91, v89, s[32:33]
  v_cndmask_b32 v44, v88, v96, s[32:33]
  v_cndmask_b32 v46, v96, v88, s[32:33]
  v_cndmask_b32 v45, v89, v97, s[32:33]
  v_add_u32 v255, s48, v13
  global_load_dwordx4 a[72:75], v255, s[6:7] offset:0
  v_cndmask_b32 v47, v97, v89, s[32:33]
  v_lshrrev_b32 v27, 2, v3
  v_lshl_add_u32 v27, v4, 2, v27
  v_lshlrev_b32 v27, 6, v27
  v_and_b32 v28, 3, v3
  v_lshl_add_u32 v27, v28, 4, v27
  v_and_b32 v28, 1, v4
  v_lshl_add_u32 v27, v28, 3, v27
  global_load_dwordx4 a[104:107], v255, s[6:7] offset:1024
  v_add_u32 v120, s21, v27
  v_xor_b32 v121, 8, v120
  v_add_u32 v122, s19, v120
  v_add_u32 v123, s19, v121
  v_add_u32 v124, s20, v120
  v_add_u32 v125, s20, v121
  v_add_u32 v27, 48, v3
  v_lshlrev_b32 v126, 2, v27
  s_waitcnt vmcnt(24)
  ds_read_b64_tr_b16 a[144:145], v120 offset:15360
  ds_read_b64_tr_b16 a[146:147], v121 offset:15360
  ds_read_b64_tr_b16 a[148:149], v122 offset:15360
  ds_read_b64_tr_b16 a[150:151], v123 offset:15360
  ds_read_b64_tr_b16 a[152:153], v120 offset:31744
  ds_read_b64_tr_b16 a[154:155], v121 offset:31744
  ds_read_b64_tr_b16 a[156:157], v124 offset:15360
  ds_read_b64_tr_b16 a[158:159], v125 offset:15360
  v_lshlrev_b32 v27, 3, v4
  v_sub_u32 v28, v3, v27
  v_sub_u32 v29, 0, v3
  v_sub_u32 v29, v29, v27
  v_add_u32 v30, 0, v28
  v_and_b32 v31, 1, v30
  v_lshlrev_b32 v31, 4, v31
  v_lshlrev_b32 v31, v31, v127
  v_lshrrev_b32 v30, 1, v30
  v_cmp_eq_u32 s[56:57], 0, v30
  v_cmp_eq_u32 s[58:59], 1, v30
  s_nop 0
  v_cndmask_b32 v48, 0, v31, s[56:57]
  v_cndmask_b32 v49, 0, v31, s[58:59]
  v_cmp_eq_u32 s[56:57], 2, v30
  v_cmp_eq_u32 s[58:59], 3, v30
  s_nop 0
  v_cndmask_b32 v50, 0, v31, s[56:57]
  v_cndmask_b32 v51, 0, v31, s[58:59]
  v_add_u32 v30, 16, v28
  v_and_b32 v31, 1, v30
  v_lshlrev_b32 v31, 4, v31
  s_waitcnt lgkmcnt(0)
  v_mfma_f32_16x16x32_bf16 v[88:91], a[144:147], v[104:107], 0
  v_mfma_f32_16x16x32_bf16 v[96:99], a[152:155], v[112:115], 0
  v_mfma_f32_16x16x32_bf16 v[88:91], a[148:151], v[108:111], v[88:91]
  v_mfma_f32_16x16x32_bf16 v[96:99], a[156:159], v[116:119], v[96:99]
  v_lshlrev_b32 v31, v31, v127
  v_lshrrev_b32 v30, 1, v30
  v_cmp_eq_u32 s[56:57], 0, v30
  v_cmp_eq_u32 s[58:59], 1, v30
  s_nop 0
  v_cndmask_b32 v52, 0, v31, s[56:57]
  v_cndmask_b32 v53, 0, v31, s[58:59]
  v_cmp_eq_u32 s[56:57], 2, v30
  v_cmp_eq_u32 s[58:59], 3, v30
  s_nop 0
  v_cndmask_b32 v54, 0, v31, s[56:57]
  v_cndmask_b32 v55, 0, v31, s[58:59]
  v_add_u32 v30, 31, v29
  v_and_b32 v31, 1, v30
  v_lshlrev_b32 v31, 4, v31
  v_lshlrev_b32 v31, v31, v127
  v_lshrrev_b32 v30, 1, v30
  v_cmp_eq_u32 s[56:57], 0, v30
  v_cmp_eq_u32 s[58:59], 1, v30
  s_nop 0
  v_cndmask_b32 v56, 0, v31, s[56:57]
  ds_bpermute_b32 v22, v126, v91
  ds_bpermute_b32 v23, v126, v99
  v_cndmask_b32 v57, 0, v31, s[58:59]
  v_cmp_eq_u32 s[56:57], 2, v30
  v_cmp_eq_u32 s[58:59], 3, v30
  s_nop 0
  v_cndmask_b32 v58, 0, v31, s[56:57]
  v_cndmask_b32 v59, 0, v31, s[58:59]
  v_add_u32 v30, 15, v29
  v_and_b32 v31, 1, v30
  v_lshlrev_b32 v31, 4, v31
  v_lshlrev_b32 v31, v31, v127
  v_lshrrev_b32 v30, 1, v30
  v_cmp_eq_u32 s[56:57], 0, v30
  v_cmp_eq_u32 s[58:59], 1, v30
  s_nop 0
  v_cndmask_b32 v60, 0, v31, s[56:57]
  v_cndmask_b32 v61, 0, v31, s[58:59]
  v_cmp_eq_u32 s[56:57], 2, v30
  v_cmp_eq_u32 s[58:59], 3, v30
  s_nop 0
  v_cndmask_b32 v62, 0, v31, s[56:57]
  v_cndmask_b32 v63, 0, v31, s[58:59]
  s_mul_i32 s42, s16, 7
  s_add_u32 s30, s42, s54
  s_lshl_b32 s30, s30, 15
  s_add_u32 s30, s30, 8388608
  s_lshl_b32 s22, s14, 2
  s_add_u32 s22, s22, 0
  s_and_b32 s23, s22, 7
  s_add_u32 s31, s23, s53
  s_cmp_ge_u32 s31, 7
  s_cselect_b32 s55, 7, 0
  s_sub_u32 s31, s31, s55
  s_cmp_eq_u32 s23, 7
  s_cselect_b32 s31, 7, s31
  s_and_b32 s22, s22, 8
  s_add_u32 s31, s31, s22
  s_lshl_b32 s31, s31, 11
  s_add_u32 s31, s31, s30
  v_add_u32 v8, s31, v5
  s_lshl_b32 s22, s14, 2
  s_add_u32 s22, s22, 1
  s_and_b32 s23, s22, 7
  s_add_u32 s31, s23, s53
  s_cmp_ge_u32 s31, 7
  s_cselect_b32 s55, 7, 0
  s_sub_u32 s31, s31, s55
  s_cmp_eq_u32 s23, 7
  s_cselect_b32 s31, 7, s31
  s_and_b32 s22, s22, 8
  s_add_u32 s31, s31, s22
  s_lshl_b32 s31, s31, 11
  s_add_u32 s31, s31, s30
  v_add_u32 v9, s31, v5
  s_lshl_b32 s22, s14, 2
  s_add_u32 s22, s22, 2
  s_and_b32 s23, s22, 7
  s_add_u32 s31, s23, s53
  s_cmp_ge_u32 s31, 7
  s_cselect_b32 s55, 7, 0
  s_sub_u32 s31, s31, s55
  s_cmp_eq_u32 s23, 7
  s_cselect_b32 s31, 7, s31
  s_and_b32 s22, s22, 8
  s_add_u32 s31, s31, s22
  s_lshl_b32 s31, s31, 11
  s_add_u32 s31, s31, s30
  v_add_u32 v25, s31, v5
  s_lshl_b32 s22, s14, 2
  s_add_u32 s22, s22, 3
  s_and_b32 s23, s22, 7
  s_add_u32 s31, s23, s53
  s_cmp_ge_u32 s31, 7
  s_cselect_b32 s55, 7, 0
  s_sub_u32 s31, s31, s55
  s_cmp_eq_u32 s23, 7
  s_cselect_b32 s31, 7, s31
  s_and_b32 s22, s22, 8
  s_add_u32 s31, s31, s22
  s_lshl_b32 s31, s31, 11
  s_add_u32 s31, s31, s30
  v_add_u32 v26, s31, v5
  s_and_b32 s22, s16, 7
  s_sub_u32 s23, s22, s53
  s_add_u32 s31, s23, 7
  s_cmp_lt_i32 s23, 0
  s_cselect_b32 s23, s31, s23
  s_cmp_eq_u32 s22, 7
  s_cselect_b32 s23, 7, s23
  s_and_b32 s22, s16, 8
  s_add_u32 s60, s23, s22
  s_lshl_b32 s22, s16, 10
  s_add_u32 s22, s22, 5242880
  v_mov_b32 v27, s17
  v_mov_b32 v28, s18
  v_cndmask_b32 v27, v27, v28, s[32:33]
  v_lshrrev_b32 v28, 1, v4
  v_lshlrev_b32 v10, 14, v27
  v_lshl_add_u32 v10, v28, 9, v10
  v_lshl_add_u32 v10, v3, 4, v10
  v_add_u32 v10, s22, v10
  s_mov_b32 s36, 57344
  v_mul_lo_u32 v11, v27, s36
  v_lshl_add_u32 v11, v28, 8, v11
  v_lshl_add_u32 v11, v3, 4, v11
  s_mov_b32 s34, 0
  s_mov_b32 s35, 0xffff0000
  s_waitcnt lgkmcnt(0)
  v_add_f32 v16, v16, v22
  v_sub_f32 v64, 0, v16
  v_sub_f32 v65, 0, v16
  v_sub_f32 v66, 0, v16
  v_sub_f32 v67, 0, v16
  v_add_f32 v18, v18, v23
  v_sub_f32 v68, 0, v18
  v_sub_f32 v69, 0, v18
  v_sub_f32 v70, 0, v18
  v_sub_f32 v71, 0, v18
  v_mov_b32 v20, 0
  v_mov_b32 v21, 0
  v_mov_b32 v22, 0
  v_mov_b32 v23, 0
  s_lshr_b32 s22, s16, 1
  s_lshl_b32 s22, s22, 2
  s_add_u32 s61, s22, s14
  s_mul_i32 s22, s61, 57344
  s_add_u32 s22, s22, 12582912
  v_add_u32 v24, s22, v5
  v_add_u32 v1, 40960, v24
  s_waitcnt vmcnt(16)
  ds_read_b64_tr_b16 a[128:129], v120 offset:0
  ds_read_b64_tr_b16 a[130:131], v121 offset:0
  ds_read_b64_tr_b16 a[132:133], v120 offset:1024
  ds_read_b64_tr_b16 a[134:135], v121 offset:1024
  ds_read_b64_tr_b16 a[136:137], v120 offset:16384
  ds_read_b64_tr_b16 a[138:139], v121 offset:16384
  ds_read_b64_tr_b16 a[140:141], v120 offset:17408
  ds_read_b64_tr_b16 a[142:143], v121 offset:17408
  s_add_u32 m0, s21, 6144
  v_add_u32 v252, s49, v6
  global_load_lds_dwordx4 v252, s[6:7] offset:0
  ds_read_b64_tr_b16 a[144:145], v122 offset:0
  ds_read_b64_tr_b16 a[146:147], v123 offset:0
  ds_read_b64_tr_b16 a[148:149], v122 offset:1024
  s_add_u32 m0, s21, 6144
  ds_read_b64_tr_b16 a[150:151], v123 offset:1024
  global_load_lds_dwordx4 v252, s[6:7] offset:1024
  ds_read_b64_tr_b16 a[152:153], v124 offset:0
  ds_read_b64_tr_b16 a[154:155], v125 offset:0
  ds_read_b64_tr_b16 a[156:157], v124 offset:1024
  ds_read_b64_tr_b16 a[158:159], v125 offset:1024
  s_add_u32 m0, s21, 22528
  v_add_u32 v253, s49, v7
  global_load_lds_dwordx4 v253, s[6:7] offset:0
  s_waitcnt lgkmcnt(8)
  v_mfma_f32_16x16x32_bf16 v[72:75], a[128:131], v[32:35], v[64:67]
  v_mfma_f32_16x16x32_bf16 v[76:79], a[132:135], v[32:35], v[64:67]
  s_add_u32 m0, s21, 22528
  v_mfma_f32_16x16x32_bf16 v[80:83], a[136:139], v[40:43], v[68:71]
  global_load_lds_dwordx4 v253, s[6:7] offset:1024
  v_mfma_f32_16x16x32_bf16 v[84:87], a[140:143], v[40:43], v[68:71]
  v_mfma_f32_16x16x32_bf16 v[72:75], v[48:51], a[0:3], v[72:75]
  v_mfma_f32_16x16x32_bf16 v[76:79], v[52:55], a[0:3], v[76:79]
  v_mfma_f32_16x16x32_bf16 v[80:83], v[48:51], a[64:67], v[80:83]
  v_mfma_f32_16x16x32_bf16 v[84:87], v[52:55], a[64:67], v[84:87]
  v_add_u32 v254, s49, v12
  global_load_dwordx4 a[12:15], v254, s[6:7] offset:0
  s_waitcnt vmcnt(13)
  ds_read_b64_tr_b16 a[128:129], v120 offset:2048
  ds_read_b64_tr_b16 a[130:131], v121 offset:2048
  ds_read_b64_tr_b16 a[132:133], v120 offset:3072
  global_load_dwordx4 a[44:47], v254, s[6:7] offset:1024
  ds_read_b64_tr_b16 a[134:135], v121 offset:3072
  ds_read_b64_tr_b16 a[136:137], v120 offset:18432
  ds_read_b64_tr_b16 a[138:139], v121 offset:18432
  ds_read_b64_tr_b16 a[140:141], v120 offset:19456
  v_add_u32 v255, s49, v13
  global_load_dwordx4 a[76:79], v255, s[6:7] offset:0
  ds_read_b64_tr_b16 a[142:143], v121 offset:19456
  s_waitcnt lgkmcnt(8)
  v_mfma_f32_16x16x32_bf16 v[88:91], a[144:147], v[36:39], v[64:67]
  v_mfma_f32_16x16x32_bf16 v[92:95], a[148:151], v[36:39], v[64:67]
  global_load_dwordx4 a[108:111], v255, s[6:7] offset:1024
  v_mfma_f32_16x16x32_bf16 v[96:99], a[152:155], v[44:47], v[68:71]
  v_cvt_pk_bf16_f32 v128, v72, v73
  v_cvt_pk_bf16_f32 v129, v74, v75
  v_cvt_pk_bf16_f32 v130, v76, v77
  v_mfma_f32_16x16x32_bf16 v[100:103], a[156:159], v[44:47], v[68:71]
  s_add_u32 m0, s21, 8192
  v_add_u32 v252, s50, v6
  global_load_lds_dwordx4 v252, s[6:7] offset:0
  v_cvt_pk_bf16_f32 v131, v78, v79
  v_cvt_pk_bf16_f32 v192, v80, v81
  v_mfma_f32_16x16x32_bf16 v[88:91], v[56:59], a[32:35], v[88:91]
  s_add_u32 m0, s21, 8192
  v_cvt_pk_bf16_f32 v193, v82, v83
  global_load_lds_dwordx4 v252, s[6:7] offset:1024
  v_cvt_pk_bf16_f32 v194, v84, v85
  v_cvt_pk_bf16_f32 v195, v86, v87
  v_mfma_f32_16x16x32_bf16 v[92:95], v[60:63], a[32:35], v[92:95]
  v_mfma_f32_16x16x32_bf16 v[112:115], v[128:131], v[128:131], 0
  s_add_u32 m0, s21, 24576
  v_add_u32 v253, s50, v7
  global_load_lds_dwordx4 v253, s[6:7] offset:0
  v_mfma_f32_16x16x32_bf16 v[116:119], v[192:195], v[192:195], 0
  v_mfma_f32_16x16x32_bf16 v[96:99], v[56:59], a[96:99], v[96:99]
  v_permlane16_swap_b32 v128, v192
  s_add_u32 m0, s21, 24576
  v_permlane16_swap_b32 v129, v193
  global_load_lds_dwordx4 v253, s[6:7] offset:1024
  v_permlane16_swap_b32 v130, v194
  v_mfma_f32_16x16x32_bf16 v[100:103], v[60:63], a[96:99], v[100:103]
  v_permlane16_swap_b32 v131, v195
  s_cmp_eq_u32 s60, 0
  s_cbranch_scc0 K2_nh0
  global_store_dwordx4 v10, v[128:131], s[6:7] sc1
  global_store_dwordx4 v10, v[192:195], s[6:7] offset:256 sc1
K2_nh0:
  s_cmp_eq_u32 s16, 0
  s_cbranch_scc0 K2_nomt
  v_add_u32 v14, 65536, v14
  v_add_u32 v15, 65536, v15
  s_mov_b64 s[36:37], exec
  s_mov_b64 exec, 0xffff
  global_store_dword v14, v16, s[6:7] sc1
  global_store_dword v15, v18, s[6:7] sc1
  s_mov_b64 exec, s[36:37]
K2_nomt:
  v_add_u32 v254, s50, v12
  global_load_dwordx4 a[16:19], v254, s[6:7] offset:0
  ds_read_b64_tr_b16 a[144:145], v122 offset:2048
  ds_read_b64_tr_b16 a[146:147], v123 offset:2048
  ds_read_b64_tr_b16 a[148:149], v122 offset:3072
  ds_read_b64_tr_b16 a[150:151], v123 offset:3072
  ds_read_b64_tr_b16 a[152:153], v124 offset:2048
  global_load_dwordx4 a[48:51], v254, s[6:7] offset:1024
  ds_read_b64_tr_b16 a[154:155], v125 offset:2048
  ds_read_b64_tr_b16 a[156:157], v124 offset:3072
  ds_read_b64_tr_b16 a[158:159], v125 offset:3072
  s_waitcnt lgkmcnt(8)
  v_mfma_f32_16x16x32_bf16 v[72:75], a[128:131], v[32:35], v[64:67]
  v_add_u32 v255, s50, v13
  global_load_dwordx4 a[80:83], v255, s[6:7] offset:0
  v_mfma_f32_16x16x32_bf16 v[76:79], a[132:135], v[32:35], v[64:67]
  v_mfma_f32_16x16x32_bf16 v[80:83], a[136:139], v[40:43], v[68:71]
  v_cvt_pk_bf16_f32 v160, v88, v89
  v_cvt_pk_bf16_f32 v161, v90, v91
  v_cvt_pk_bf16_f32 v162, v92, v93
  v_mfma_f32_16x16x32_bf16 v[84:87], a[140:143], v[40:43], v[68:71]
  global_load_dwordx4 a[112:115], v255, s[6:7] offset:1024
  v_cvt_pk_bf16_f32 v163, v94, v95
  v_cvt_pk_bf16_f32 v224, v96, v97
  v_mfma_f32_16x16x32_bf16 v[72:75], v[48:51], a[4:7], v[72:75]
  v_cvt_pk_bf16_f32 v225, v98, v99
  v_cvt_pk_bf16_f32 v226, v100, v101
  s_add_u32 m0, s21, 10240
  v_add_u32 v252, s51, v6
  global_load_lds_dwordx4 v252, s[6:7] offset:0
  v_cvt_pk_bf16_f32 v227, v102, v103
  v_mfma_f32_16x16x32_bf16 v[76:79], v[52:55], a[4:7], v[76:79]
  v_mfma_f32_16x16x32_bf16 v[112:115], v[160:163], v[160:163], v[112:115]
  v_mfma_f32_16x16x32_bf16 v[116:119], v[224:227], v[224:227], v[116:119]
  v_mfma_f32_16x16x32_bf16 v[80:83], v[48:51], a[68:71], v[80:83]
  s_add_u32 m0, s21, 10240
  v_permlane16_swap_b32 v160, v224
  global_load_lds_dwordx4 v252, s[6:7] offset:1024
  v_permlane16_swap_b32 v161, v225
  v_permlane16_swap_b32 v162, v226
  v_mfma_f32_16x16x32_bf16 v[84:87], v[52:55], a[68:71], v[84:87]
  v_permlane16_swap_b32 v163, v227
  s_cmp_eq_u32 s60, 8
  s_cbranch_scc0 K2_nh8
  global_store_dwordx4 v10, v[160:163], s[6:7] sc1
  global_store_dwordx4 v10, v[224:227], s[6:7] offset:256 sc1
K2_nh8:
  s_add_u32 m0, s21, 26624
  v_add_u32 v253, s51, v7
  global_load_lds_dwordx4 v253, s[6:7] offset:0
  s_waitcnt vmcnt(19)
  ds_read_b64_tr_b16 a[128:129], v120 offset:4096
  ds_read_b64_tr_b16 a[130:131], v121 offset:4096
  ds_read_b64_tr_b16 a[132:133], v120 offset:5120
  s_add_u32 m0, s21, 26624
  ds_read_b64_tr_b16 a[134:135], v121 offset:5120
  global_load_lds_dwordx4 v253, s[6:7] offset:1024
  ds_read_b64_tr_b16 a[136:137], v120 offset:20480
  ds_read_b64_tr_b16 a[138:139], v121 offset:20480
  ds_read_b64_tr_b16 a[140:141], v120 offset:21504
  ds_read_b64_tr_b16 a[142:143], v121 offset:21504
  s_waitcnt lgkmcnt(8)
  v_mfma_f32_16x16x32_bf16 v[88:91], a[144:147], v[36:39], v[64:67]
  v_add_u32 v254, s51, v12
  global_load_dwordx4 a[20:23], v254, s[6:7] offset:0
  v_mfma_f32_16x16x32_bf16 v[92:95], a[148:151], v[36:39], v[64:67]
  v_mfma_f32_16x16x32_bf16 v[96:99], a[152:155], v[44:47], v[68:71]
  v_cvt_pk_bf16_f32 v132, v72, v73
  v_cvt_pk_bf16_f32 v133, v74, v75
  v_cvt_pk_bf16_f32 v134, v76, v77
  global_load_dwordx4 a[52:55], v254, s[6:7] offset:1024
  v_mfma_f32_16x16x32_bf16 v[100:103], a[156:159], v[44:47], v[68:71]
  v_cvt_pk_bf16_f32 v135, v78, v79
  v_cvt_pk_bf16_f32 v196, v80, v81
  v_mfma_f32_16x16x32_bf16 v[88:91], v[56:59], a[36:39], v[88:91]
  v_cvt_pk_bf16_f32 v197, v82, v83
  v_cvt_pk_bf16_f32 v198, v84, v85
  v_add_u32 v255, s51, v13
  global_load_dwordx4 a[84:87], v255, s[6:7] offset:0
  v_cvt_pk_bf16_f32 v199, v86, v87
  v_mfma_f32_16x16x32_bf16 v[92:95], v[60:63], a[36:39], v[92:95]
  v_mfma_f32_16x16x32_bf16 v[112:115], v[132:135], v[132:135], v[112:115]
  v_mfma_f32_16x16x32_bf16 v[116:119], v[196:199], v[196:199], v[116:119]
  v_mfma_f32_16x16x32_bf16 v[96:99], v[56:59], a[100:103], v[96:99]
  global_load_dwordx4 a[116:119], v255, s[6:7] offset:1024
  v_permlane16_swap_b32 v132, v196
  v_permlane16_swap_b32 v133, v197
  v_permlane16_swap_b32 v134, v198
  v_mfma_f32_16x16x32_bf16 v[100:103], v[60:63], a[100:103], v[100:103]
  v_permlane16_swap_b32 v135, v199
  s_cmp_eq_u32 s60, 1
  s_cbranch_scc0 K2_nh1
  global_store_dwordx4 v10, v[132:135], s[6:7] sc1
  global_store_dwordx4 v10, v[196:199], s[6:7] offset:256 sc1
K2_nh1:
  s_add_u32 m0, s21, 12288
  v_add_u32 v252, s52, v6
  global_load_lds_dwordx4 v252, s[6:7] offset:0
  ds_read_b64_tr_b16 a[144:145], v122 offset:4096
  ds_read_b64_tr_b16 a[146:147], v123 offset:4096
  ds_read_b64_tr_b16 a[148:149], v122 offset:5120
  ds_read_b64_tr_b16 a[150:151], v123 offset:5120
  ds_read_b64_tr_b16 a[152:153], v124 offset:4096
  ds_read_b64_tr_b16 a[154:155], v125 offset:4096
  ds_read_b64_tr_b16 a[156:157], v124 offset:5120
  s_add_u32 m0, s21, 12288
  ds_read_b64_tr_b16 a[158:159], v125 offset:5120
  global_load_lds_dwordx4 v252, s[6:7] offset:1024
  s_waitcnt lgkmcnt(8)
  v_mfma_f32_16x16x32_bf16 v[72:75], a[128:131], v[32:35], v[64:67]
  v_mfma_f32_16x16x32_bf16 v[76:79], a[132:135], v[32:35], v[64:67]
  v_mfma_f32_16x16x32_bf16 v[80:83], a[136:139], v[40:43], v[68:71]
  v_cvt_pk_bf16_f32 v164, v88, v89
  v_cvt_pk_bf16_f32 v165, v90, v91
  v_cvt_pk_bf16_f32 v166, v92, v93
  v_mfma_f32_16x16x32_bf16 v[84:87], a[140:143], v[40:43], v[68:71]
  s_add_u32 m0, s21, 28672
  v_add_u32 v253, s52, v7
  global_load_lds_dwordx4 v253, s[6:7] offset:0
  v_cvt_pk_bf16_f32 v167, v94, v95
  v_cvt_pk_bf16_f32 v228, v96, v97
  v_mfma_f32_16x16x32_bf16 v[72:75], v[48:51], a[8:11], v[72:75]
  v_cvt_pk_bf16_f32 v229, v98, v99
  v_cvt_pk_bf16_f32 v230, v100, v101
  v_cvt_pk_bf16_f32 v231, v102, v103
  v_mfma_f32_16x16x32_bf16 v[76:79], v[52:55], a[8:11], v[76:79]
  s_add_u32 m0, s21, 28672
  v_mfma_f32_16x16x32_bf16 v[112:115], v[164:167], v[164:167], v[112:115]
  global_load_lds_dwordx4 v253, s[6:7] offset:1024
  v_mfma_f32_16x16x32_bf16 v[116:119], v[228:231], v[228:231], v[116:119]
  v_mfma_f32_16x16x32_bf16 v[80:83], v[48:51], a[72:75], v[80:83]
  v_permlane16_swap_b32 v164, v228
  v_permlane16_swap_b32 v165, v229
  v_permlane16_swap_b32 v166, v230
  v_mfma_f32_16x16x32_bf16 v[84:87], v[52:55], a[72:75], v[84:87]
  v_permlane16_swap_b32 v167, v231
  s_cmp_eq_u32 s60, 9
  s_cbranch_scc0 K2_nh9
  global_store_dwordx4 v10, v[164:167], s[6:7] sc1
  global_store_dwordx4 v10, v[228:231], s[6:7] offset:256 sc1
K2_nh9:
  v_add_u32 v254, s52, v12
  global_load_dwordx4 a[24:27], v254, s[6:7] offset:0
  s_waitcnt vmcnt(21)
  ds_read_b64_tr_b16 a[128:129], v120 offset:6144
  ds_read_b64_tr_b16 a[130:131], v121 offset:6144
  ds_read_b64_tr_b16 a[132:133], v120 offset:7168
  ds_read_b64_tr_b16 a[134:135], v121 offset:7168
  ds_read_b64_tr_b16 a[136:137], v120 offset:22528
  ds_read_b64_tr_b16 a[138:139], v121 offset:22528
  ds_read_b64_tr_b16 a[140:141], v120 offset:23552
  global_load_dwordx4 a[56:59], v254, s[6:7] offset:1024
  ds_read_b64_tr_b16 a[142:143], v121 offset:23552
  s_waitcnt lgkmcnt(8)
  v_mfma_f32_16x16x32_bf16 v[88:91], a[144:147], v[36:39], v[64:67]
  v_mfma_f32_16x16x32_bf16 v[92:95], a[148:151], v[36:39], v[64:67]
  v_mfma_f32_16x16x32_bf16 v[96:99], a[152:155], v[44:47], v[68:71]
  v_cvt_pk_bf16_f32 v136, v72, v73
  v_cvt_pk_bf16_f32 v137, v74, v75
  v_cvt_pk_bf16_f32 v138, v76, v77
  v_add_u32 v255, s52, v13
  global_load_dwordx4 a[88:91], v255, s[6:7] offset:0
  v_mfma_f32_16x16x32_bf16 v[100:103], a[156:159], v[44:47], v[68:71]
  v_cvt_pk_bf16_f32 v139, v78, v79
  v_cvt_pk_bf16_f32 v200, v80, v81
  v_mfma_f32_16x16x32_bf16 v[88:91], v[56:59], a[40:43], v[88:91]
  v_cvt_pk_bf16_f32 v201, v82, v83
  v_cvt_pk_bf16_f32 v202, v84, v85
  v_cvt_pk_bf16_f32 v203, v86, v87
  v_mfma_f32_16x16x32_bf16 v[92:95], v[60:63], a[40:43], v[92:95]
  global_load_dwordx4 a[120:123], v255, s[6:7] offset:1024
  v_mfma_f32_16x16x32_bf16 v[112:115], v[136:139], v[136:139], v[112:115]
  v_mfma_f32_16x16x32_bf16 v[116:119], v[200:203], v[200:203], v[116:119]
  v_mfma_f32_16x16x32_bf16 v[96:99], v[56:59], a[104:107], v[96:99]
  v_permlane16_swap_b32 v136, v200
  v_permlane16_swap_b32 v137, v201
  v_permlane16_swap_b32 v138, v202
  v_mfma_f32_16x16x32_bf16 v[100:103], v[60:63], a[104:107], v[100:103]
  v_permlane16_swap_b32 v139, v203
  s_cmp_eq_u32 s60, 2
  s_cbranch_scc0 K2_nh2
  global_store_dwordx4 v10, v[136:139], s[6:7] sc1
  global_store_dwordx4 v10, v[200:203], s[6:7] offset:256 sc1
K2_nh2:
  s_add_u32 m0, s21, 12288
  s_nop 0
  global_load_lds_dwordx4 v6, s[28:29] offset:2048
  ds_read_b64_tr_b16 a[144:145], v122 offset:6144
  ds_read_b64_tr_b16 a[146:147], v123 offset:6144
  ds_read_b64_tr_b16 a[148:149], v122 offset:7168
  ds_read_b64_tr_b16 a[150:151], v123 offset:7168
  ds_read_b64_tr_b16 a[152:153], v124 offset:6144
  ds_read_b64_tr_b16 a[154:155], v125 offset:6144
  ds_read_b64_tr_b16 a[156:157], v124 offset:7168
  ds_read_b64_tr_b16 a[158:159], v125 offset:7168
  s_waitcnt lgkmcnt(8)
  s_add_u32 m0, s21, 28672
  v_mfma_f32_16x16x32_bf16 v[72:75], a[128:131], v[32:35], v[64:67]
  global_load_lds_dwordx4 v7, s[28:29] offset:2048
  v_mfma_f32_16x16x32_bf16 v[76:79], a[132:135], v[32:35], v[64:67]
  v_mfma_f32_16x16x32_bf16 v[80:83], a[136:139], v[40:43], v[68:71]
  v_cvt_pk_bf16_f32 v168, v88, v89
  v_cvt_pk_bf16_f32 v169, v90, v91
  v_cvt_pk_bf16_f32 v170, v92, v93
  v_mfma_f32_16x16x32_bf16 v[84:87], a[140:143], v[40:43], v[68:71]
  v_cvt_pk_bf16_f32 v171, v94, v95
  v_cvt_pk_bf16_f32 v232, v96, v97
  v_mfma_f32_16x16x32_bf16 v[72:75], v[48:51], a[12:15], v[72:75]
  v_cvt_pk_bf16_f32 v233, v98, v99
  v_cvt_pk_bf16_f32 v234, v100, v101
  global_load_dwordx4 a[28:31], v12, s[28:29] offset:2048
  v_cvt_pk_bf16_f32 v235, v102, v103
  v_mfma_f32_16x16x32_bf16 v[76:79], v[52:55], a[12:15], v[76:79]
  v_mfma_f32_16x16x32_bf16 v[112:115], v[168:171], v[168:171], v[112:115]
  v_mfma_f32_16x16x32_bf16 v[116:119], v[232:235], v[232:235], v[116:119]
  v_mfma_f32_16x16x32_bf16 v[80:83], v[48:51], a[76:79], v[80:83]
  v_permlane16_swap_b32 v168, v232
  v_permlane16_swap_b32 v169, v233
  v_permlane16_swap_b32 v170, v234
  v_mfma_f32_16x16x32_bf16 v[84:87], v[52:55], a[76:79], v[84:87]
  v_permlane16_swap_b32 v171, v235
  s_cmp_eq_u32 s60, 10
  s_cbranch_scc0 K2_nh10
  global_store_dwordx4 v10, v[168:171], s[6:7] sc1
  global_store_dwordx4 v10, v[232:235], s[6:7] offset:256 sc1
K2_nh10:
  global_load_dwordx4 a[60:63], v12, s[28:29] offset:3072
  s_waitcnt vmcnt(20)
  ds_read_b64_tr_b16 a[128:129], v120 offset:8192
  ds_read_b64_tr_b16 a[130:131], v121 offset:8192
  ds_read_b64_tr_b16 a[132:133], v120 offset:9216
  ds_read_b64_tr_b16 a[134:135], v121 offset:9216
  ds_read_b64_tr_b16 a[136:137], v120 offset:24576
  ds_read_b64_tr_b16 a[138:139], v121 offset:24576
  ds_read_b64_tr_b16 a[140:141], v120 offset:25600
  ds_read_b64_tr_b16 a[142:143], v121 offset:25600
  s_waitcnt lgkmcnt(8)
  v_mfma_f32_16x16x32_bf16 v[88:91], a[144:147], v[36:39], v[64:67]
  global_load_dwordx4 a[92:95], v13, s[28:29] offset:2048
  v_mfma_f32_16x16x32_bf16 v[92:95], a[148:151], v[36:39], v[64:67]
  v_mfma_f32_16x16x32_bf16 v[96:99], a[152:155], v[44:47], v[68:71]
  v_cvt_pk_bf16_f32 v140, v72, v73
  v_cvt_pk_bf16_f32 v141, v74, v75
  v_cvt_pk_bf16_f32 v142, v76, v77
  v_mfma_f32_16x16x32_bf16 v[100:103], a[156:159], v[44:47], v[68:71]
  v_cvt_pk_bf16_f32 v143, v78, v79
  v_cvt_pk_bf16_f32 v204, v80, v81
  v_mfma_f32_16x16x32_bf16 v[88:91], v[56:59], a[44:47], v[88:91]
  v_cvt_pk_bf16_f32 v205, v82, v83
  v_cvt_pk_bf16_f32 v206, v84, v85
  global_load_dwordx4 a[124:127], v13, s[28:29] offset:3072
  v_cvt_pk_bf16_f32 v207, v86, v87
  v_mfma_f32_16x16x32_bf16 v[92:95], v[60:63], a[44:47], v[92:95]
  v_mfma_f32_16x16x32_bf16 v[112:115], v[140:143], v[140:143], v[112:115]
  v_mfma_f32_16x16x32_bf16 v[116:119], v[204:207], v[204:207], v[116:119]
  v_mfma_f32_16x16x32_bf16 v[96:99], v[56:59], a[108:111], v[96:99]
  v_permlane16_swap_b32 v140, v204
  v_permlane16_swap_b32 v141, v205
  v_permlane16_swap_b32 v142, v206
  v_mfma_f32_16x16x32_bf16 v[100:103], v[60:63], a[108:111], v[100:103]
  v_permlane16_swap_b32 v143, v207
  s_cmp_eq_u32 s60, 3
  s_cbranch_scc0 K2_nh3
  global_store_dwordx4 v10, v[140:143], s[6:7] sc1
  global_store_dwordx4 v10, v[204:207], s[6:7] offset:256 sc1
K2_nh3:
  global_load_dwordx4 a[192:195], v1, s[6:7] offset:0
  ds_read_b64_tr_b16 a[144:145], v122 offset:8192
  ds_read_b64_tr_b16 a[146:147], v123 offset:8192
  ds_read_b64_tr_b16 a[148:149], v122 offset:9216
  ds_read_b64_tr_b16 a[150:151], v123 offset:9216
  ds_read_b64_tr_b16 a[152:153], v124 offset:8192
  ds_read_b64_tr_b16 a[154:155], v125 offset:8192
  ds_read_b64_tr_b16 a[156:157], v124 offset:9216
  ds_read_b64_tr_b16 a[158:159], v125 offset:9216
  global_load_dwordx4 a[196:199], v1, s[6:7] offset:1024
  s_waitcnt lgkmcnt(8)
  v_mfma_f32_16x16x32_bf16 v[72:75], a[128:131], v[32:35], v[64:67]
  v_mfma_f32_16x16x32_bf16 v[76:79], a[132:135], v[32:35], v[64:67]
  v_mfma_f32_16x16x32_bf16 v[80:83], a[136:139], v[40:43], v[68:71]
  v_cvt_pk_bf16_f32 v172, v88, v89
  v_cvt_pk_bf16_f32 v173, v90, v91
  v_cvt_pk_bf16_f32 v174, v92, v93
  v_mfma_f32_16x16x32_bf16 v[84:87], a[140:143], v[40:43], v[68:71]
  global_load_dwordx4 a[200:203], v1, s[6:7] offset:2048
  v_cvt_pk_bf16_f32 v175, v94, v95
  v_cvt_pk_bf16_f32 v236, v96, v97
  v_mfma_f32_16x16x32_bf16 v[72:75], v[48:51], a[16:19], v[72:75]
  v_cvt_pk_bf16_f32 v237, v98, v99
  v_cvt_pk_bf16_f32 v238, v100, v101
  v_cvt_pk_bf16_f32 v239, v102, v103
  v_mfma_f32_16x16x32_bf16 v[76:79], v[52:55], a[16:19], v[76:79]
  v_mfma_f32_16x16x32_bf16 v[112:115], v[172:175], v[172:175], v[112:115]
  global_load_dwordx4 a[204:207], v1, s[6:7] offset:3072
  v_add_u32 v1, 0x1000, v1
  v_mfma_f32_16x16x32_bf16 v[116:119], v[236:239], v[236:239], v[116:119]
  v_mfma_f32_16x16x32_bf16 v[80:83], v[48:51], a[80:83], v[80:83]
  v_permlane16_swap_b32 v172, v236
  v_permlane16_swap_b32 v173, v237
  v_permlane16_swap_b32 v174, v238
  v_mfma_f32_16x16x32_bf16 v[84:87], v[52:55], a[80:83], v[84:87]
  v_permlane16_swap_b32 v175, v239
  s_cmp_eq_u32 s60, 11
  s_cbranch_scc0 K2_nh11
  global_store_dwordx4 v10, v[172:175], s[6:7] sc1
  global_store_dwordx4 v10, v[236:239], s[6:7] offset:256 sc1
K2_nh11:
  global_load_dwordx4 a[208:211], v1, s[6:7] offset:0
  s_waitcnt vmcnt(19)
  ds_read_b64_tr_b16 a[128:129], v120 offset:10240
  ds_read_b64_tr_b16 a[130:131], v121 offset:10240
  ds_read_b64_tr_b16 a[132:133], v120 offset:11264
  ds_read_b64_tr_b16 a[134:135], v121 offset:11264
  ds_read_b64_tr_b16 a[136:137], v120 offset:26624
  ds_read_b64_tr_b16 a[138:139], v121 offset:26624
  ds_read_b64_tr_b16 a[140:141], v120 offset:27648
  global_load_dwordx4 a[212:215], v1, s[6:7] offset:1024
  ds_read_b64_tr_b16 a[142:143], v121 offset:27648
  s_waitcnt lgkmcnt(8)
  v_mfma_f32_16x16x32_bf16 v[88:91], a[144:147], v[36:39], v[64:67]
  v_mfma_f32_16x16x32_bf16 v[92:95], a[148:151], v[36:39], v[64:67]
  v_mfma_f32_16x16x32_bf16 v[96:99], a[152:155], v[44:47], v[68:71]
  v_cvt_pk_bf16_f32 v144, v72, v73
  v_cvt_pk_bf16_f32 v145, v74, v75
  v_cvt_pk_bf16_f32 v146, v76, v77
  global_load_dwordx4 a[216:219], v1, s[6:7] offset:2048
  v_mfma_f32_16x16x32_bf16 v[100:103], a[156:159], v[44:47], v[68:71]
  v_cvt_pk_bf16_f32 v147, v78, v79
  v_cvt_pk_bf16_f32 v208, v80, v81
  v_mfma_f32_16x16x32_bf16 v[88:91], v[56:59], a[48:51], v[88:91]
  v_cvt_pk_bf16_f32 v209, v82, v83
  v_cvt_pk_bf16_f32 v210, v84, v85
  v_cvt_pk_bf16_f32 v211, v86, v87
  v_mfma_f32_16x16x32_bf16 v[92:95], v[60:63], a[48:51], v[92:95]
  global_load_dwordx4 a[220:223], v1, s[6:7] offset:3072
  v_add_u32 v1, 0x1000, v1
  v_mfma_f32_16x16x32_bf16 v[112:115], v[144:147], v[144:147], v[112:115]
  v_mfma_f32_16x16x32_bf16 v[116:119], v[208:211], v[208:211], v[116:119]
  v_mfma_f32_16x16x32_bf16 v[96:99], v[56:59], a[112:115], v[96:99]
  v_permlane16_swap_b32 v144, v208
  v_permlane16_swap_b32 v145, v209
  v_permlane16_swap_b32 v146, v210
  v_mfma_f32_16x16x32_bf16 v[100:103], v[60:63], a[112:115], v[100:103]
  v_permlane16_swap_b32 v147, v211
  s_cmp_eq_u32 s60, 4
  s_cbranch_scc0 K2_nh4
  global_store_dwordx4 v10, v[144:147], s[6:7] sc1
  global_store_dwordx4 v10, v[208:211], s[6:7] offset:256 sc1
K2_nh4:
  s_add_u32 m0, s21, 32768
  s_nop 0
  global_load_lds_dwordx4 v8, s[6:7]
  global_load_lds_dwordx4 v8, s[6:7] offset:1024
  v_add_u32 v8, 0x8000, v8
  ds_read_b64_tr_b16 a[144:145], v122 offset:10240
  ds_read_b64_tr_b16 a[146:147], v123 offset:10240
  ds_read_b64_tr_b16 a[148:149], v122 offset:11264
  ds_read_b64_tr_b16 a[150:151], v123 offset:11264
  ds_read_b64_tr_b16 a[152:153], v124 offset:10240
  ds_read_b64_tr_b16 a[154:155], v125 offset:10240
  ds_read_b64_tr_b16 a[156:157], v124 offset:11264
  ds_read_b64_tr_b16 a[158:159], v125 offset:11264
  s_waitcnt lgkmcnt(8)
  v_mfma_f32_16x16x32_bf16 v[72:75], a[128:131], v[32:35], v[64:67]
  v_mfma_f32_16x16x32_bf16 v[76:79], a[132:135], v[32:35], v[64:67]
  v_mfma_f32_16x16x32_bf16 v[80:83], a[136:139], v[40:43], v[68:71]
  v_cvt_pk_bf16_f32 v176, v88, v89
  v_cvt_pk_bf16_f32 v177, v90, v91
  v_cvt_pk_bf16_f32 v178, v92, v93
  s_add_u32 m0, s21, 34816
  v_mfma_f32_16x16x32_bf16 v[84:87], a[140:143], v[40:43], v[68:71]
  global_load_lds_dwordx4 v9, s[6:7]
  global_load_lds_dwordx4 v9, s[6:7] offset:1024
  v_add_u32 v9, 0x8000, v9
  v_cvt_pk_bf16_f32 v179, v94, v95
  v_cvt_pk_bf16_f32 v240, v96, v97
  v_mfma_f32_16x16x32_bf16 v[72:75], v[48:51], a[20:23], v[72:75]
  v_cvt_pk_bf16_f32 v241, v98, v99
  v_cvt_pk_bf16_f32 v242, v100, v101
  v_cvt_pk_bf16_f32 v243, v102, v103
  v_mfma_f32_16x16x32_bf16 v[76:79], v[52:55], a[20:23], v[76:79]
  v_mfma_f32_16x16x32_bf16 v[112:115], v[176:179], v[176:179], v[112:115]
  v_mfma_f32_16x16x32_bf16 v[116:119], v[240:243], v[240:243], v[116:119]
  v_mfma_f32_16x16x32_bf16 v[80:83], v[48:51], a[84:87], v[80:83]
  v_permlane16_swap_b32 v176, v240
  v_permlane16_swap_b32 v177, v241
  v_permlane16_swap_b32 v178, v242
  v_mfma_f32_16x16x32_bf16 v[84:87], v[52:55], a[84:87], v[84:87]
  v_permlane16_swap_b32 v179, v243
  s_cmp_eq_u32 s60, 12
  s_cbranch_scc0 K2_nh12
  global_store_dwordx4 v10, v[176:179], s[6:7] sc1
  global_store_dwordx4 v10, v[240:243], s[6:7] offset:256 sc1
K2_nh12:
  s_add_u32 m0, s21, 36864
  s_nop 0
  global_load_lds_dwordx4 v25, s[6:7]
  global_load_lds_dwordx4 v25, s[6:7] offset:1024
  v_add_u32 v25, 0x8000, v25
  s_waitcnt vmcnt(20)
  ds_read_b64_tr_b16 a[128:129], v120 offset:12288
  ds_read_b64_tr_b16 a[130:131], v121 offset:12288
  ds_read_b64_tr_b16 a[132:133], v120 offset:13312
  ds_read_b64_tr_b16 a[134:135], v121 offset:13312
  ds_read_b64_tr_b16 a[136:137], v120 offset:28672
  ds_read_b64_tr_b16 a[138:139], v121 offset:28672
  ds_read_b64_tr_b16 a[140:141], v120 offset:29696
  ds_read_b64_tr_b16 a[142:143], v121 offset:29696
  s_waitcnt lgkmcnt(8)
  v_mfma_f32_16x16x32_bf16 v[88:91], a[144:147], v[36:39], v[64:67]
  v_mfma_f32_16x16x32_bf16 v[92:95], a[148:151], v[36:39], v[64:67]
  v_mfma_f32_16x16x32_bf16 v[96:99], a[152:155], v[44:47], v[68:71]
  v_cvt_pk_bf16_f32 v148, v72, v73
  v_cvt_pk_bf16_f32 v149, v74, v75
  s_add_u32 m0, s21, 38912
  v_cvt_pk_bf16_f32 v150, v76, v77
  global_load_lds_dwordx4 v26, s[6:7]
  global_load_lds_dwordx4 v26, s[6:7] offset:1024
  v_add_u32 v26, 0x8000, v26
  v_mfma_f32_16x16x32_bf16 v[100:103], a[156:159], v[44:47], v[68:71]
  v_cvt_pk_bf16_f32 v151, v78, v79
  v_cvt_pk_bf16_f32 v212, v80, v81
  v_mfma_f32_16x16x32_bf16 v[88:91], v[56:59], a[52:55], v[88:91]
  v_cvt_pk_bf16_f32 v213, v82, v83
  v_cvt_pk_bf16_f32 v214, v84, v85
  v_cvt_pk_bf16_f32 v215, v86, v87
  v_mfma_f32_16x16x32_bf16 v[92:95], v[60:63], a[52:55], v[92:95]
  v_mfma_f32_16x16x32_bf16 v[112:115], v[148:151], v[148:151], v[112:115]
  v_mfma_f32_16x16x32_bf16 v[116:119], v[212:215], v[212:215], v[116:119]
  v_mfma_f32_16x16x32_bf16 v[96:99], v[56:59], a[116:119], v[96:99]
  v_permlane16_swap_b32 v148, v212
  v_permlane16_swap_b32 v149, v213
  v_permlane16_swap_b32 v150, v214
  v_mfma_f32_16x16x32_bf16 v[100:103], v[60:63], a[116:119], v[100:103]
  v_permlane16_swap_b32 v151, v215
  s_cmp_eq_u32 s60, 5
  s_cbranch_scc0 K2_nh5
  global_store_dwordx4 v10, v[148:151], s[6:7] sc1
  global_store_dwordx4 v10, v[212:215], s[6:7] offset:256 sc1
K2_nh5:
  global_load_dwordx4 a[224:227], v1, s[6:7] offset:0
  ds_read_b64_tr_b16 a[144:145], v122 offset:12288
  ds_read_b64_tr_b16 a[146:147], v123 offset:12288
  ds_read_b64_tr_b16 a[148:149], v122 offset:13312
  ds_read_b64_tr_b16 a[150:151], v123 offset:13312
  ds_read_b64_tr_b16 a[152:153], v124 offset:12288
  ds_read_b64_tr_b16 a[154:155], v125 offset:12288
  ds_read_b64_tr_b16 a[156:157], v124 offset:13312
  ds_read_b64_tr_b16 a[158:159], v125 offset:13312
  global_load_dwordx4 a[228:231], v1, s[6:7] offset:1024
  s_waitcnt lgkmcnt(8)
  v_mfma_f32_16x16x32_bf16 v[72:75], a[128:131], v[32:35], v[64:67]
  v_mfma_f32_16x16x32_bf16 v[76:79], a[132:135], v[32:35], v[64:67]
  v_mfma_f32_16x16x32_bf16 v[80:83], a[136:139], v[40:43], v[68:71]
  v_cvt_pk_bf16_f32 v180, v88, v89
  v_cvt_pk_bf16_f32 v181, v90, v91
  v_cvt_pk_bf16_f32 v182, v92, v93
  v_mfma_f32_16x16x32_bf16 v[84:87], a[140:143], v[40:43], v[68:71]
  global_load_dwordx4 a[232:235], v1, s[6:7] offset:2048
  v_cvt_pk_bf16_f32 v183, v94, v95
  v_cvt_pk_bf16_f32 v244, v96, v97
  v_mfma_f32_16x16x32_bf16 v[72:75], v[48:51], a[24:27], v[72:75]
  v_cvt_pk_bf16_f32 v245, v98, v99
  v_cvt_pk_bf16_f32 v246, v100, v101
  v_cvt_pk_bf16_f32 v247, v102, v103
  v_mfma_f32_16x16x32_bf16 v[76:79], v[52:55], a[24:27], v[76:79]
  v_mfma_f32_16x16x32_bf16 v[112:115], v[180:183], v[180:183], v[112:115]
  global_load_dwordx4 a[236:239], v1, s[6:7] offset:3072
  v_add_u32 v1, 0x1000, v1
  v_mfma_f32_16x16x32_bf16 v[116:119], v[244:247], v[244:247], v[116:119]
  v_mfma_f32_16x16x32_bf16 v[80:83], v[48:51], a[88:91], v[80:83]
  v_permlane16_swap_b32 v180, v244
  v_permlane16_swap_b32 v181, v245
  v_permlane16_swap_b32 v182, v246
  v_mfma_f32_16x16x32_bf16 v[84:87], v[52:55], a[88:91], v[84:87]
  v_permlane16_swap_b32 v183, v247
  s_cmp_eq_u32 s60, 13
  s_cbranch_scc0 K2_nh13
  global_store_dwordx4 v10, v[180:183], s[6:7] sc1
  global_store_dwordx4 v10, v[244:247], s[6:7] offset:256 sc1
K2_nh13:
  global_load_dwordx4 a[240:243], v1, s[6:7] offset:0
  s_waitcnt vmcnt(21)
  ds_read_b64_tr_b16 a[128:129], v120 offset:14336
  ds_read_b64_tr_b16 a[130:131], v121 offset:14336
  ds_read_b64_tr_b16 a[132:133], v120 offset:15360
  ds_read_b64_tr_b16 a[134:135], v121 offset:15360
  ds_read_b64_tr_b16 a[136:137], v120 offset:30720
  ds_read_b64_tr_b16 a[138:139], v121 offset:30720
  ds_read_b64_tr_b16 a[140:141], v120 offset:31744
  global_load_dwordx4 a[244:247], v1, s[6:7] offset:1024
  ds_read_b64_tr_b16 a[142:143], v121 offset:31744
  s_waitcnt lgkmcnt(8)
  v_mfma_f32_16x16x32_bf16 v[88:91], a[144:147], v[36:39], v[64:67]
  v_mfma_f32_16x16x32_bf16 v[92:95], a[148:151], v[36:39], v[64:67]
  v_mfma_f32_16x16x32_bf16 v[96:99], a[152:155], v[44:47], v[68:71]
  v_cvt_pk_bf16_f32 v152, v72, v73
  v_cvt_pk_bf16_f32 v153, v74, v75
  v_cvt_pk_bf16_f32 v154, v76, v77
  global_load_dwordx4 a[248:251], v1, s[6:7] offset:2048
  v_mfma_f32_16x16x32_bf16 v[100:103], a[156:159], v[44:47], v[68:71]
  v_cvt_pk_bf16_f32 v155, v78, v79
  v_cvt_pk_bf16_f32 v216, v80, v81
  v_mfma_f32_16x16x32_bf16 v[88:91], v[56:59], a[56:59], v[88:91]
  v_cvt_pk_bf16_f32 v217, v82, v83
  v_cvt_pk_bf16_f32 v218, v84, v85
  v_cvt_pk_bf16_f32 v219, v86, v87
  v_mfma_f32_16x16x32_bf16 v[92:95], v[60:63], a[56:59], v[92:95]
  global_load_dwordx4 a[252:255], v1, s[6:7] offset:3072
  v_add_u32 v1, 0x1000, v1
  v_mfma_f32_16x16x32_bf16 v[112:115], v[152:155], v[152:155], v[112:115]
  v_mfma_f32_16x16x32_bf16 v[116:119], v[216:219], v[216:219], v[116:119]
  v_mfma_f32_16x16x32_bf16 v[96:99], v[56:59], a[120:123], v[96:99]
  v_permlane16_swap_b32 v152, v216
  v_permlane16_swap_b32 v153, v217
  v_permlane16_swap_b32 v154, v218
  v_mfma_f32_16x16x32_bf16 v[100:103], v[60:63], a[120:123], v[100:103]
  v_permlane16_swap_b32 v155, v219
  s_cmp_eq_u32 s60, 6
  s_cbranch_scc0 K2_nh6
  global_store_dwordx4 v10, v[152:155], s[6:7] sc1
  global_store_dwordx4 v10, v[216:219], s[6:7] offset:256 sc1
K2_nh6:
  s_add_u32 m0, s21, 0
  s_nop 0
  global_load_lds_dwordx4 v8, s[6:7]
  global_load_lds_dwordx4 v8, s[6:7] offset:1024
  v_add_u32 v8, 0x8000, v8
  ds_read_b64_tr_b16 a[144:145], v122 offset:14336
  ds_read_b64_tr_b16 a[146:147], v123 offset:14336
  ds_read_b64_tr_b16 a[148:149], v122 offset:15360
  ds_read_b64_tr_b16 a[150:151], v123 offset:15360
  ds_read_b64_tr_b16 a[152:153], v124 offset:14336
  ds_read_b64_tr_b16 a[154:155], v125 offset:14336
  ds_read_b64_tr_b16 a[156:157], v124 offset:15360
  ds_read_b64_tr_b16 a[158:159], v125 offset:15360
  s_waitcnt lgkmcnt(8)
  s_add_u32 m0, s21, 2048
  v_mfma_f32_16x16x32_bf16 v[72:75], a[128:131], v[32:35], v[64:67]
  global_load_lds_dwordx4 v9, s[6:7]
  global_load_lds_dwordx4 v9, s[6:7] offset:1024
  v_add_u32 v9, 0x8000, v9
  v_mfma_f32_16x16x32_bf16 v[76:79], a[132:135], v[32:35], v[64:67]
  v_mfma_f32_16x16x32_bf16 v[80:83], a[136:139], v[40:43], v[68:71]
  v_cvt_pk_bf16_f32 v184, v88, v89
  v_cvt_pk_bf16_f32 v185, v90, v91
  v_cvt_pk_bf16_f32 v186, v92, v93
  v_mfma_f32_16x16x32_bf16 v[84:87], a[140:143], v[40:43], v[68:71]
  v_cvt_pk_bf16_f32 v187, v94, v95
  v_cvt_pk_bf16_f32 v248, v96, v97
  v_mfma_f32_16x16x32_bf16 v[72:75], v[48:51], a[28:31], v[72:75]
  s_add_u32 m0, s21, 4096
  v_cvt_pk_bf16_f32 v249, v98, v99
  global_load_lds_dwordx4 v25, s[6:7]
  global_load_lds_dwordx4 v25, s[6:7] offset:1024
  v_add_u32 v25, 0x8000, v25
  v_cvt_pk_bf16_f32 v250, v100, v101
  v_cvt_pk_bf16_f32 v251, v102, v103
  v_mfma_f32_16x16x32_bf16 v[76:79], v[52:55], a[28:31], v[76:79]
  v_mfma_f32_16x16x32_bf16 v[112:115], v[184:187], v[184:187], v[112:115]
  v_mfma_f32_16x16x32_bf16 v[116:119], v[248:251], v[248:251], v[116:119]
  v_mfma_f32_16x16x32_bf16 v[80:83], v[48:51], a[92:95], v[80:83]
  v_permlane16_swap_b32 v184, v248
  v_permlane16_swap_b32 v185, v249
  v_permlane16_swap_b32 v186, v250
  s_add_u32 m0, s21, 6144
  v_mfma_f32_16x16x32_bf16 v[84:87], v[52:55], a[92:95], v[84:87]
  global_load_lds_dwordx4 v26, s[6:7]
  global_load_lds_dwordx4 v26, s[6:7] offset:1024
  v_add_u32 v26, 0x8000, v26
  v_permlane16_swap_b32 v187, v251
  s_cmp_eq_u32 s60, 14
  s_cbranch_scc0 K2_nh14
  global_store_dwordx4 v10, v[184:187], s[6:7] sc1
  global_store_dwordx4 v10, v[248:251], s[6:7] offset:256 sc1
K2_nh14:
  s_waitcnt lgkmcnt(0)
  v_mfma_f32_16x16x32_bf16 v[88:91], a[144:147], v[36:39], v[64:67]
  v_mfma_f32_16x16x32_bf16 v[92:95], a[148:151], v[36:39], v[64:67]
  v_mfma_f32_16x16x32_bf16 v[96:99], a[152:155], v[44:47], v[68:71]
  v_mfma_f32_16x16x32_bf16 v[100:103], a[156:159], v[44:47], v[68:71]
  v_mfma_f32_16x16x32_bf16 v[88:91], v[56:59], a[60:63], v[88:91]
  v_mfma_f32_16x16x32_bf16 v[92:95], v[60:63], a[60:63], v[92:95]
  v_mfma_f32_16x16x32_bf16 v[96:99], v[56:59], a[124:127], v[96:99]
  v_mfma_f32_16x16x32_bf16 v[100:103], v[60:63], a[124:127], v[100:103]
  s_nop 5
  v_add_f32 v27, v79, v95
  v_mul_f32 v27, 0.5, v27
  v_sub_f32 v28, v17, v16
  v_cndmask_b32 v79, v79, v27, s[34:35]
  v_cndmask_b32 v95, v95, v28, s[34:35]
  v_add_f32 v27, v87, v103
  v_mul_f32 v27, 0.5, v27
  v_sub_f32 v28, v19, v18
  v_cndmask_b32 v87, v87, v27, s[34:35]
  v_cndmask_b32 v103, v103, v28, s[34:35]
  v_cvt_pk_bf16_f32 v156, v72, v73
  v_cvt_pk_bf16_f32 v157, v74, v75
  v_cvt_pk_bf16_f32 v158, v76, v77
  v_cvt_pk_bf16_f32 v159, v78, v79
  v_cvt_pk_bf16_f32 v220, v80, v81
  v_cvt_pk_bf16_f32 v221, v82, v83
  v_cvt_pk_bf16_f32 v222, v84, v85
  v_cvt_pk_bf16_f32 v223, v86, v87
  v_mfma_f32_16x16x32_bf16 v[112:115], v[156:159], v[156:159], v[112:115]
  s_nop 0
  v_mfma_f32_16x16x32_bf16 v[116:119], v[220:223], v[220:223], v[116:119]
  v_permlane16_swap_b32 v156, v220
  v_permlane16_swap_b32 v157, v221
  v_permlane16_swap_b32 v158, v222
  v_permlane16_swap_b32 v159, v223
  s_cmp_eq_u32 s60, 7
  s_cbranch_scc0 K2_nh7
  global_store_dwordx4 v10, v[156:159], s[6:7] sc1
  global_store_dwordx4 v10, v[220:223], s[6:7] offset:256 sc1
K2_nh7:
  v_cvt_pk_bf16_f32 v188, v88, v89
  v_cvt_pk_bf16_f32 v189, v90, v91
  v_cvt_pk_bf16_f32 v190, v92, v93
  v_cvt_pk_bf16_f32 v191, v94, v95
  v_cvt_pk_bf16_f32 v252, v96, v97
  v_cvt_pk_bf16_f32 v253, v98, v99
  v_cvt_pk_bf16_f32 v254, v100, v101
  v_cvt_pk_bf16_f32 v255, v102, v103
  v_mfma_f32_16x16x32_bf16 v[112:115], v[188:191], v[188:191], v[112:115]
  s_nop 0
  v_mfma_f32_16x16x32_bf16 v[116:119], v[252:255], v[252:255], v[116:119]
  v_permlane16_swap_b32 v188, v252
  v_permlane16_swap_b32 v189, v253
  v_permlane16_swap_b32 v190, v254
  v_permlane16_swap_b32 v191, v255
  s_cmp_eq_u32 s60, 15
  s_cbranch_scc0 K2_nh15
  global_store_dwordx4 v10, v[188:191], s[6:7] sc1
  global_store_dwordx4 v10, v[252:255], s[6:7] offset:256 sc1
K2_nh15:
  v_add_u32 v32, 0, v5
  v_add_u32 v33, 40960, v5
  v_add_u32 v34, 81920, v5
  v_add_u32 v35, 122880, v5
  v_and_b32 v27, 3, v3
  v_cmp_eq_u32 s[56:57], 1, v27
  v_cmp_eq_u32 s[58:59], 2, v27
  v_cmp_eq_u32 vcc, 3, v27
  v_cndmask_b32 v20, v112, v113, s[56:57]
  v_cndmask_b32 v22, v116, v117, s[56:57]
  v_cndmask_b32 v20, v20, v114, s[58:59]
  v_cndmask_b32 v22, v22, v118, s[58:59]
  v_cndmask_b32 v20, v20, v115, vcc
  v_cndmask_b32 v22, v22, v119, vcc
  v_lshrrev_b32 v27, 2, v3
  v_lshl_add_u32 v27, v27, 4, v3
  v_lshlrev_b32 v27, 2, v27
  ds_bpermute_b32 v21, v27, v20
  ds_bpermute_b32 v23, v27, v22
  s_mov_b32 s38, 0x3b000000
  v_mov_b32 v27, 0x3727c5ac
  s_waitcnt lgkmcnt(0)
  v_cndmask_b32 v20, v21, v23, s[32:33]
  v_fma_f32 v20, v20, s38, v27
  v_rsq_f32 v20, v20
  s_nop 0
  v_mul_f32 v21, 0xbfb8aa3b, v20
  s_waitcnt vmcnt(16)
  s_barrier
  ds_read_b128 a[160:163], v32 offset:32768
  ds_read_b128 a[164:167], v32 offset:33792
  ds_read_b128 a[168:171], v32 offset:34816
  ds_read_b128 a[172:175], v32 offset:35840
  ds_read_b128 a[176:179], v32 offset:36864
  ds_read_b128 a[180:183], v32 offset:37888
  ds_read_b128 a[184:187], v32 offset:38912
  ds_read_b128 a[188:191], v32 offset:39936
  s_waitcnt lgkmcnt(6)
  v_mfma_f32_32x32x16_bf16 v[72:87], a[160:163], v[128:131], 0
  global_load_dwordx4 a[0:3], v24, s[6:7] offset:0
  s_and_b32 s22, s16, 1
  s_lshl_b32 s22, s22, 1
  s_lshl_b32 s23, s15, 2
  s_add_u32 s46, s22, s23
  s_sub_u32 s47, 128, s46
  s_cmp_eq_u32 s46, 0
  s_cselect_b32 s47, 64, s47
  s_add_u32 s48, s46, 1
  s_sub_u32 s49, 128, s48
  s_cmp_eq_u32 s14, 1
  s_cselect_b32 s50, s47, s46
  s_cmp_eq_u32 s14, 2
  s_cselect_b32 s50, s48, s50
  s_cmp_eq_u32 s14, 3
  s_cselect_b32 s50, s49, s50
  s_mul_i32 s22, s50, 57344
  s_add_u32 s22, s22, 16777216
  v_add_u32 v7, s22, v5
  s_add_u32 s24, s6, 4096
  s_addc_u32 s25, s7, 0
  s_lshr_b32 s30, s61, 1
  s_lshl_b32 s31, s61, 4
  s_sub_u32 s32, 496, s31
  s_lshr_b32 s32, s32, 5
  s_add_u32 s32, s32, 8
  s_cmp_lt_u32 s61, 16
  s_cselect_b32 s30, s30, s32
  s_sub_u32 s33, s30, 1
  s_cmp_eq_u32 s61, 0
  s_cselect_b32 s33, 15, s33
  s_cmp_eq_u32 s61, 16
  s_cselect_b32 s33, 7, s33
  s_max_i32 s33, s33, 0
  s_and_b32 s34, s61, 1
  s_cmp_gt_u32 s61, 16
  s_cselect_b32 s34, 1, s34
  s_lshl_b32 s52, s30, 10
  s_add_u32 s52, s52, 5242880
  v_add_u32 v14, s52, v5
  s_lshl_b32 s52, s33, 10
  s_add_u32 s52, s52, 5242880
  v_add_u32 v15, s52, v5
  v_mfma_f32_32x32x16_bf16 v[72:87], a[164:167], v[192:195], v[72:87]
  v_lshlrev_b32 v6, 2, v3
  v_add_u32 v6, 2162688, v6
  ds_read_b128 a[160:163], v33 offset:32768
  ds_read_b128 a[164:167], v33 offset:33792
  s_waitcnt lgkmcnt(6)
  s_add_u32 m0, s21, 16384
  v_mfma_f32_32x32x16_bf16 v[72:87], a[168:171], v[132:135], v[72:87]
  global_load_lds_dwordx4 v8, s[6:7]
  global_load_lds_dwordx4 v8, s[6:7] offset:1024
  v_add_u32 v8, 0x8000, v8
  v_lshlrev_b32 v12, 17, v3
  v_mov_b32 v13, s61
  v_mfma_f32_32x32x16_bf16 v[72:87], a[172:175], v[196:199], v[72:87]
  v_lshl_add_u32 v12, v13, 5, v12
  v_lshl_add_u32 v12, v4, 3, v12
  ds_read_b128 a[168:171], v33 offset:34816
  ds_read_b128 a[172:175], v33 offset:35840
  s_waitcnt lgkmcnt(6)
  v_mfma_f32_32x32x16_bf16 v[72:87], a[176:179], v[136:139], v[72:87]
  global_load_dwordx4 a[4:7], v24, s[6:7] offset:1024
  v_add_u32 v16, s31, v3
  v_mfma_f32_32x32x16_bf16 v[72:87], a[180:183], v[200:203], v[72:87]
  v_mov_b32 v23, 0x3f80
  s_and_b32 s52, s30, 7
  s_lshl_b32 s52, s52, 5
  s_sub_u32 s56, -1, s52
  s_sub_u32 s57, 511, s52
  s_cmp_lt_u32 s30, 8
  s_cselect_b32 s56, s56, s57
  s_cselect_b32 s57, 1, -1
  s_cmp_eq_u32 s30, 15
  s_cselect_b32 s58, 0, -1
  s_cselect_b32 s59, 256, -1
  v_mul_lo_u32 v17, v16, s57
  ds_read_b128 a[176:179], v33 offset:36864
  ds_read_b128 a[180:183], v33 offset:37888
  s_waitcnt lgkmcnt(6)
  v_mfma_f32_32x32x16_bf16 v[72:87], a[184:187], v[140:143], v[72:87]
  s_add_u32 m0, s21, 18432
  v_add_u32 v17, s56, v17
  global_load_lds_dwordx4 v9, s[6:7]
  global_load_lds_dwordx4 v9, s[6:7] offset:1024
  v_add_u32 v9, 0x8000, v9
  v_mfma_f32_32x32x16_bf16 v[72:87], a[188:191], v[204:207], v[72:87]
  v_cmp_eq_u32 vcc, s59, v16
  s_nop 1
  v_cndmask_b32 v17, v17, -1, vcc
  ds_read_b128 a[184:187], v33 offset:38912
  ds_read_b128 a[188:191], v33 offset:39936
  s_waitcnt lgkmcnt(6)
  v_mfma_f32_32x32x16_bf16 v[72:87], a[160:163], v[144:147], v[72:87]
  v_cmp_eq_u32 vcc, s58, v16
  s_nop 1
  v_cndmask_b32 v17, v17, 31, vcc
  global_load_dwordx4 a[8:11], v24, s[6:7] offset:2048
  v_mfma_f32_32x32x16_bf16 v[72:87], a[164:167], v[208:211], v[72:87]
  v_bfe_u32 v18, v17, 2, 2
  v_cmp_eq_u32 vcc, v18, v4
  ds_read_b128 a[160:163], v34 offset:32768
  ds_read_b128 a[164:167], v34 offset:33792
  s_waitcnt lgkmcnt(6)
  v_mfma_f32_32x32x16_bf16 v[72:87], a[168:171], v[148:151], v[72:87]
  v_cndmask_b32 v17, -1, v17, vcc
  v_lshrrev_b32 v18, 4, v17
  s_add_u32 m0, s21, 20480
  v_mfma_f32_32x32x16_bf16 v[72:87], a[172:175], v[212:215], v[72:87]
  global_load_lds_dwordx4 v25, s[6:7]
  global_load_lds_dwordx4 v25, s[6:7] offset:1024
  v_add_u32 v25, 0x8000, v25
  v_lshlrev_b32 v18, 1, v18
  v_bfe_u32 v19, v17, 1, 1
  ds_read_b128 a[168:171], v34 offset:34816
  ds_read_b128 a[172:175], v34 offset:35840
  s_waitcnt lgkmcnt(6)
  v_mfma_f32_32x32x16_bf16 v[72:87], a[176:179], v[152:155], v[72:87]
  v_add_u32 v18, v18, v19
  v_and_b32 v19, 1, v17
  v_mfma_f32_32x32x16_bf16 v[72:87], a[180:183], v[216:219], v[72:87]
  s_add_u32 m0, s21, 22528
  v_lshlrev_b32 v19, 4, v19
  global_load_lds_dwordx4 v26, s[6:7]
  global_load_lds_dwordx4 v26, s[6:7] offset:1024
  v_add_u32 v26, 0x8000, v26
  ds_read_b128 a[176:179], v34 offset:36864
  ds_read_b128 a[180:183], v34 offset:37888
  s_waitcnt lgkmcnt(6)
  v_mfma_f32_32x32x16_bf16 v[72:87], a[184:187], v[156:159], v[72:87]
  v_lshlrev_b32 v19, v19, v23
  v_cmp_eq_u32 vcc, 0, v18
  s_nop 1
  v_cndmask_b32 v104, 0, v19, vcc
  v_mfma_f32_32x32x16_bf16 v[72:87], a[188:191], v[220:223], v[72:87]
  v_cmp_eq_u32 vcc, 1, v18
  global_load_dwordx4 a[12:15], v24, s[6:7] offset:3072
  v_add_u32 v24, 0x1000, v24
  ds_read_b128 a[184:187], v34 offset:38912
  ds_read_b128 a[188:191], v34 offset:39936
  s_waitcnt lgkmcnt(6)
  v_mfma_f32_32x32x16_bf16 v[72:87], a[160:163], v[160:163], v[72:87]
  v_cndmask_b32 v105, 0, v19, vcc
  v_cmp_eq_u32 vcc, 2, v18
  v_mfma_f32_32x32x16_bf16 v[72:87], a[164:167], v[224:227], v[72:87]
  s_nop 0
  v_cndmask_b32 v106, 0, v19, vcc
  v_cmp_eq_u32 vcc, 3, v18
  s_add_u32 m0, s21, 8192
  s_nop 0
  global_load_lds_dwordx4 v8, s[6:7]
  global_load_lds_dwordx4 v8, s[6:7] offset:1024
  v_add_u32 v8, 0x8000, v8
  ds_read_b128 a[160:163], v35 offset:32768
  ds_read_b128 a[164:167], v35 offset:33792
  s_waitcnt lgkmcnt(6)
  v_mfma_f32_32x32x16_bf16 v[72:87], a[168:171], v[164:167], v[72:87]
  v_cndmask_b32 v107, 0, v19, vcc
  s_and_b32 s52, s33, 7
  s_lshl_b32 s52, s52, 5
  s_sub_u32 s56, -1, s52
  s_sub_u32 s57, 511, s52
  s_cmp_lt_u32 s33, 8
  s_cselect_b32 s56, s56, s57
  s_cselect_b32 s57, 1, -1
  s_cmp_eq_u32 s33, 15
  s_cselect_b32 s58, 0, -1
  s_cselect_b32 s59, 256, -1
  v_mfma_f32_32x32x16_bf16 v[72:87], a[172:175], v[228:231], v[72:87]
  v_mul_lo_u32 v17, v16, s57
  v_add_u32 v17, s56, v17
  ds_read_b128 a[168:171], v35 offset:34816
  ds_read_b128 a[172:175], v35 offset:35840
  s_waitcnt lgkmcnt(6)
  v_mfma_f32_32x32x16_bf16 v[72:87], a[176:179], v[168:171], v[72:87]
  v_cmp_eq_u32 vcc, s59, v16
  global_load_dwordx4 a[16:19], v24, s[6:7] offset:0
  s_nop 0
  v_cndmask_b32 v17, v17, -1, vcc
  v_mfma_f32_32x32x16_bf16 v[72:87], a[180:183], v[232:235], v[72:87]
  v_cmp_eq_u32 vcc, s58, v16
  s_nop 1
  v_cndmask_b32 v17, v17, 31, vcc
  ds_read_b128 a[176:179], v35 offset:36864
  ds_read_b128 a[180:183], v35 offset:37888
  s_waitcnt lgkmcnt(6)
  v_mfma_f32_32x32x16_bf16 v[72:87], a[184:187], v[172:175], v[72:87]
  s_cmp_eq_u32 s34, 1
  s_cselect_b32 s52, -1, 0
  s_add_u32 m0, s21, 10240
  v_or_b32 v17, s52, v17
  global_load_lds_dwordx4 v9, s[6:7]
  global_load_lds_dwordx4 v9, s[6:7] offset:1024
  v_add_u32 v9, 0x8000, v9
  v_mfma_f32_32x32x16_bf16 v[72:87], a[188:191], v[236:239], v[72:87]
  v_bfe_u32 v18, v17, 2, 2
  v_cmp_eq_u32 vcc, v18, v4
  s_nop 1
  v_cndmask_b32 v17, -1, v17, vcc
  ds_read_b128 a[184:187], v35 offset:38912
  ds_read_b128 a[188:191], v35 offset:39936
  s_waitcnt lgkmcnt(6)
  v_mfma_f32_32x32x16_bf16 v[72:87], a[160:163], v[176:179], v[72:87]
  v_lshrrev_b32 v18, 4, v17
  global_load_dwordx4 a[20:23], v24, s[6:7] offset:1024
  v_mfma_f32_32x32x16_bf16 v[72:87], a[164:167], v[240:243], v[72:87]
  v_lshlrev_b32 v18, 1, v18
  v_bfe_u32 v19, v17, 1, 1
  s_waitcnt lgkmcnt(4)
  v_mfma_f32_32x32x16_bf16 v[72:87], a[168:171], v[180:183], v[72:87]
  v_add_u32 v18, v18, v19
  v_and_b32 v19, 1, v17
  v_lshlrev_b32 v19, 4, v19
  s_add_u32 m0, s21, 12288
  v_mfma_f32_32x32x16_bf16 v[72:87], a[172:175], v[244:247], v[72:87]
  global_load_lds_dwordx4 v25, s[6:7]
  global_load_lds_dwordx4 v25, s[6:7] offset:1024
  v_add_u32 v25, 0x8000, v25
  v_lshlrev_b32 v19, v19, v23
  s_waitcnt lgkmcnt(2)
  v_mfma_f32_32x32x16_bf16 v[72:87], a[176:179], v[184:187], v[72:87]
  v_cmp_eq_u32 vcc, 0, v18
  s_nop 1
  v_cndmask_b32 v108, 0, v19, vcc
  v_mfma_f32_32x32x16_bf16 v[72:87], a[180:183], v[248:251], v[72:87]
  v_cmp_eq_u32 vcc, 1, v18
  s_add_u32 m0, s21, 14336
  s_nop 0
  global_load_lds_dwordx4 v26, s[6:7]
  global_load_lds_dwordx4 v26, s[6:7] offset:1024
  v_add_u32 v26, 0x8000, v26
  v_cndmask_b32 v109, 0, v19, vcc
  s_waitcnt lgkmcnt(0)
  v_mfma_f32_32x32x16_bf16 v[72:87], a[184:187], v[188:191], v[72:87]
  v_cmp_eq_u32 vcc, 2, v18
  s_nop 1
  v_cndmask_b32 v110, 0, v19, vcc
  v_mfma_f32_32x32x16_bf16 v[72:87], a[188:191], v[252:255], v[72:87]
  v_cmp_eq_u32 vcc, 3, v18
  s_nop 1
  v_cndmask_b32 v111, 0, v19, vcc
  s_waitcnt vmcnt(22)
  s_barrier
  ds_read_b128 a[160:163], v32 offset:0
  ds_read_b128 a[164:167], v32 offset:1024
  ds_read_b128 a[168:171], v32 offset:2048
  ds_read_b128 a[172:175], v32 offset:3072
  ds_read_b128 a[176:179], v32 offset:4096
  ds_read_b128 a[180:183], v32 offset:5120
  ds_read_b128 a[184:187], v32 offset:6144
  ds_read_b128 a[188:191], v32 offset:7168
  s_waitcnt lgkmcnt(6)
  v_mfma_f32_32x32x16_bf16 v[88:103], a[160:163], v[128:131], 0
  global_load_dwordx4 a[24:27], v24, s[6:7] offset:2048
  s_lshl_b32 s44, s16, 10
  s_add_u32 s44, s44, 16777216
  s_add_u32 s40, s6, s44
  s_addc_u32 s41, s7, 0
  v_mfma_f32_32x32x16_bf16 v[88:103], a[164:167], v[192:195], v[88:103]
  v_mul_f32 v40, v21, v72
  v_mul_f32 v41, v21, v73
  ds_read_b128 a[160:163], v33 offset:0
  ds_read_b128 a[164:167], v33 offset:1024
  s_waitcnt lgkmcnt(6)
  v_mfma_f32_32x32x16_bf16 v[88:103], a[168:171], v[132:135], v[88:103]
  v_mul_f32 v42, v21, v74
  v_mul_f32 v43, v21, v75
  v_mfma_f32_32x32x16_bf16 v[88:103], a[172:175], v[196:199], v[88:103]
  global_load_dwordx4 a[28:31], v24, s[6:7] offset:3072
  v_add_u32 v24, 0x1000, v24
  v_mul_f32 v44, v21, v76
  ds_read_b128 a[168:171], v33 offset:2048
  ds_read_b128 a[172:175], v33 offset:3072
  s_waitcnt lgkmcnt(6)
  v_mfma_f32_32x32x16_bf16 v[88:103], a[176:179], v[136:139], v[88:103]
  v_mul_f32 v45, v21, v77
  v_mul_f32 v46, v21, v78
  v_mfma_f32_32x32x16_bf16 v[88:103], a[180:183], v[200:203], v[88:103]
  v_mul_f32 v47, v21, v79
  v_exp_f32 v40, v40
  ds_read_b128 a[176:179], v33 offset:4096
  ds_read_b128 a[180:183], v33 offset:5120
  s_waitcnt lgkmcnt(6)
  s_add_u32 m0, s21, 24576
  v_mfma_f32_32x32x16_bf16 v[88:103], a[184:187], v[140:143], v[88:103]
  global_load_lds_dwordx4 v8, s[6:7]
  global_load_lds_dwordx4 v8, s[6:7] offset:1024
  v_add_u32 v8, 0x8000, v8
  v_mul_f32 v48, v20, v80
  v_mfma_f32_32x32x16_bf16 v[88:103], a[188:191], v[204:207], v[88:103]
  v_exp_f32 v41, v41
  v_mul_f32 v49, v20, v81
  ds_read_b128 a[184:187], v33 offset:6144
  ds_read_b128 a[188:191], v33 offset:7168
  s_waitcnt lgkmcnt(6)
  v_mfma_f32_32x32x16_bf16 v[88:103], a[160:163], v[144:147], v[88:103]
  v_exp_f32 v42, v42
  v_mul_f32 v50, v20, v82
  v_mfma_f32_32x32x16_bf16 v[88:103], a[164:167], v[208:211], v[88:103]
  v_exp_f32 v43, v43
  global_load_dwordx4 a[32:35], v24, s[6:7] offset:0
  ds_read_b128 a[160:163], v34 offset:0
  ds_read_b128 a[164:167], v34 offset:1024
  s_waitcnt lgkmcnt(6)
  v_mfma_f32_32x32x16_bf16 v[88:103], a[168:171], v[148:151], v[88:103]
  v_mul_f32 v51, v20, v83
  v_exp_f32 v44, v44
  v_mfma_f32_32x32x16_bf16 v[88:103], a[172:175], v[212:215], v[88:103]
  v_mul_f32 v52, v20, v84
  v_exp_f32 v45, v45
  ds_read_b128 a[168:171], v34 offset:2048
  ds_read_b128 a[172:175], v34 offset:3072
  s_waitcnt lgkmcnt(6)
  v_mfma_f32_32x32x16_bf16 v[88:103], a[176:179], v[152:155], v[88:103]
  s_add_u32 m0, s21, 26624
  v_mul_f32 v53, v20, v85
  global_load_lds_dwordx4 v9, s[6:7]
  global_load_lds_dwordx4 v9, s[6:7] offset:1024
  v_add_u32 v9, 0x8000, v9
  v_mfma_f32_32x32x16_bf16 v[88:103], a[180:183], v[216:219], v[88:103]
  v_exp_f32 v46, v46
  v_mul_f32 v54, v20, v86
  ds_read_b128 a[176:179], v34 offset:4096
  ds_read_b128 a[180:183], v34 offset:5120
  s_waitcnt lgkmcnt(6)
  v_mfma_f32_32x32x16_bf16 v[88:103], a[184:187], v[156:159], v[88:103]
  v_exp_f32 v47, v47
  v_mul_f32 v55, v20, v87
  v_mfma_f32_32x32x16_bf16 v[88:103], a[188:191], v[220:223], v[88:103]
  v_add_f32 v40, 1.0, v40
  v_add_f32 v41, 1.0, v41
  ds_read_b128 a[184:187], v34 offset:6144
  ds_read_b128 a[188:191], v34 offset:7168
  s_waitcnt lgkmcnt(6)
  v_mfma_f32_32x32x16_bf16 v[88:103], a[160:163], v[160:163], v[88:103]
  global_load_dwordx4 a[36:39], v24, s[6:7] offset:1024
  v_add_f32 v42, 1.0, v42
  v_mfma_f32_32x32x16_bf16 v[88:103], a[164:167], v[224:227], v[88:103]
  v_add_f32 v43, 1.0, v43
  v_add_f32 v44, 1.0, v44
  ds_read_b128 a[160:163], v35 offset:0
  ds_read_b128 a[164:167], v35 offset:1024
  s_waitcnt lgkmcnt(6)
  v_mfma_f32_32x32x16_bf16 v[88:103], a[168:171], v[164:167], v[88:103]
  v_add_f32 v45, 1.0, v45
  v_add_f32 v46, 1.0, v46
  v_mfma_f32_32x32x16_bf16 v[88:103], a[172:175], v[228:231], v[88:103]
  global_load_dwordx4 a[40:43], v24, s[6:7] offset:2048
  v_add_f32 v47, 1.0, v47
  ds_read_b128 a[168:171], v35 offset:2048
  ds_read_b128 a[172:175], v35 offset:3072
  s_waitcnt lgkmcnt(6)
  v_mfma_f32_32x32x16_bf16 v[88:103], a[176:179], v[168:171], v[88:103]
  v_rcp_f32 v40, v40
  v_rcp_f32 v41, v41
  v_mfma_f32_32x32x16_bf16 v[88:103], a[180:183], v[232:235], v[88:103]
  v_rcp_f32 v42, v42
  v_rcp_f32 v43, v43
  ds_read_b128 a[176:179], v35 offset:4096
  ds_read_b128 a[180:183], v35 offset:5120
  s_waitcnt lgkmcnt(6)
  s_add_u32 m0, s21, 28672
  v_mfma_f32_32x32x16_bf16 v[88:103], a[184:187], v[172:175], v[88:103]
  global_load_lds_dwordx4 v25, s[6:7]
  global_load_lds_dwordx4 v25, s[6:7] offset:1024
  v_add_u32 v25, 0x8000, v25
  v_rcp_f32 v44, v44
  v_mfma_f32_32x32x16_bf16 v[88:103], a[188:191], v[236:239], v[88:103]
  v_rcp_f32 v45, v45
  v_rcp_f32 v46, v46
  ds_read_b128 a[184:187], v35 offset:6144
  ds_read_b128 a[188:191], v35 offset:7168
  s_waitcnt lgkmcnt(6)
  v_mfma_f32_32x32x16_bf16 v[88:103], a[160:163], v[176:179], v[88:103]
  v_rcp_f32 v47, v47
  v_mul_f32 v40, v40, v48
  v_mfma_f32_32x32x16_bf16 v[88:103], a[164:167], v[240:243], v[88:103]
  v_mul_f32 v41, v41, v49
  global_load_dwordx4 a[44:47], v24, s[6:7] offset:3072
  v_add_u32 v24, 0x1000, v24
  s_waitcnt lgkmcnt(4)
  v_mfma_f32_32x32x16_bf16 v[88:103], a[168:171], v[180:183], v[88:103]
  v_mul_f32 v42, v42, v50
  v_mul_f32 v43, v43, v51
  v_mfma_f32_32x32x16_bf16 v[88:103], a[172:175], v[244:247], v[88:103]
  v_mul_f32 v44, v44, v52
  v_mul_f32 v45, v45, v53
  s_waitcnt lgkmcnt(2)
  v_mfma_f32_32x32x16_bf16 v[88:103], a[176:179], v[184:187], v[88:103]
  s_add_u32 m0, s21, 30720
  v_mul_f32 v46, v46, v54
  global_load_lds_dwordx4 v26, s[6:7]
  global_load_lds_dwordx4 v26, s[6:7] offset:1024
  v_add_u32 v26, 0x8000, v26
  v_mfma_f32_32x32x16_bf16 v[88:103], a[180:183], v[248:251], v[88:103]
  v_mul_f32 v47, v47, v55
  v_cvt_pk_bf16_f32 v56, v40, v41
  s_waitcnt lgkmcnt(0)
  v_mfma_f32_32x32x16_bf16 v[88:103], a[184:187], v[188:191], v[88:103]
  v_cvt_pk_bf16_f32 v57, v42, v43
  v_cvt_pk_bf16_f32 v58, v44, v45
  v_mfma_f32_32x32x16_bf16 v[88:103], a[188:191], v[252:255], v[88:103]
  v_cvt_pk_bf16_f32 v59, v46, v47
  global_store_dwordx4 v11, v[56:59], s[40:41] sc1
  s_waitcnt vmcnt(15)
  s_barrier
  ds_read_b128 a[160:163], v32 offset:16384
  ds_read_b128 a[164:167], v32 offset:17408
  ds_read_b128 a[168:171], v32 offset:18432
  ds_read_b128 a[172:175], v32 offset:19456
  ds_read_b128 a[176:179], v32 offset:20480
  ds_read_b128 a[180:183], v32 offset:21504
  ds_read_b128 a[184:187], v32 offset:22528
  ds_read_b128 a[188:191], v32 offset:23552
  s_waitcnt lgkmcnt(6)
  v_mfma_f32_32x32x16_bf16 v[72:87], a[160:163], v[128:131], 0
  global_load_dwordx4 a[48:51], v24, s[6:7] offset:0
  s_lshl_b32 s44, s16, 10
  s_add_u32 s44, s44, 16777728
  s_add_u32 s40, s6, s44
  s_addc_u32 s41, s7, 0
  v_mfma_f32_32x32x16_bf16 v[72:87], a[164:167], v[192:195], v[72:87]
  v_mul_f32 v40, v21, v88
  v_mul_f32 v41, v21, v89
  ds_read_b128 a[160:163], v33 offset:16384
  ds_read_b128 a[164:167], v33 offset:17408
  s_waitcnt lgkmcnt(6)
  v_mfma_f32_32x32x16_bf16 v[72:87], a[168:171], v[132:135], v[72:87]
  v_mul_f32 v42, v21, v90
  v_mul_f32 v43, v21, v91
  v_mfma_f32_32x32x16_bf16 v[72:87], a[172:175], v[196:199], v[72:87]
  global_load_dwordx4 a[52:55], v24, s[6:7] offset:1024
  v_mul_f32 v44, v21, v92
  ds_read_b128 a[168:171], v33 offset:18432
  ds_read_b128 a[172:175], v33 offset:19456
  s_waitcnt lgkmcnt(6)
  v_mfma_f32_32x32x16_bf16 v[72:87], a[176:179], v[136:139], v[72:87]
  v_mul_f32 v45, v21, v93
  v_mul_f32 v46, v21, v94
  v_mfma_f32_32x32x16_bf16 v[72:87], a[180:183], v[200:203], v[72:87]
  v_mul_f32 v47, v21, v95
  v_exp_f32 v40, v40
  ds_read_b128 a[176:179], v33 offset:20480
  ds_read_b128 a[180:183], v33 offset:21504
  s_waitcnt lgkmcnt(6)
  s_add_u32 m0, s21, 32768
  v_mfma_f32_32x32x16_bf16 v[72:87], a[184:187], v[140:143], v[72:87]
  global_load_lds_dwordx4 v8, s[6:7]
  global_load_lds_dwordx4 v8, s[6:7] offset:1024
  v_add_u32 v8, 0x8000, v8
  v_mul_f32 v48, v20, v96
  v_mfma_f32_32x32x16_bf16 v[72:87], a[188:191], v[204:207], v[72:87]
  v_exp_f32 v41, v41
  v_mul_f32 v49, v20, v97
  ds_read_b128 a[184:187], v33 offset:22528
  ds_read_b128 a[188:191], v33 offset:23552
  s_waitcnt lgkmcnt(6)
  v_mfma_f32_32x32x16_bf16 v[72:87], a[160:163], v[144:147], v[72:87]
  v_exp_f32 v42, v42
  v_mul_f32 v50, v20, v98
  v_mfma_f32_32x32x16_bf16 v[72:87], a[164:167], v[208:211], v[72:87]
  v_exp_f32 v43, v43
  global_load_dwordx4 a[56:59], v24, s[6:7] offset:2048
  ds_read_b128 a[160:163], v34 offset:16384
  ds_read_b128 a[164:167], v34 offset:17408
  s_waitcnt lgkmcnt(6)
  v_mfma_f32_32x32x16_bf16 v[72:87], a[168:171], v[148:151], v[72:87]
  v_mul_f32 v51, v20, v99
  v_exp_f32 v44, v44
  v_mfma_f32_32x32x16_bf16 v[72:87], a[172:175], v[212:215], v[72:87]
  v_mul_f32 v52, v20, v100
  v_exp_f32 v45, v45
  ds_read_b128 a[168:171], v34 offset:18432
  ds_read_b128 a[172:175], v34 offset:19456
  s_waitcnt lgkmcnt(6)
  v_mfma_f32_32x32x16_bf16 v[72:87], a[176:179], v[152:155], v[72:87]
  s_add_u32 m0, s21, 34816
  v_mul_f32 v53, v20, v101
  global_load_lds_dwordx4 v9, s[6:7]
  global_load_lds_dwordx4 v9, s[6:7] offset:1024
  v_add_u32 v9, 0x8000, v9
  v_mfma_f32_32x32x16_bf16 v[72:87], a[180:183], v[216:219], v[72:87]
  v_exp_f32 v46, v46
  v_mul_f32 v54, v20, v102
  ds_read_b128 a[176:179], v34 offset:20480
  ds_read_b128 a[180:183], v34 offset:21504
  s_waitcnt lgkmcnt(6)
  v_mfma_f32_32x32x16_bf16 v[72:87], a[184:187], v[156:159], v[72:87]
  v_exp_f32 v47, v47
  v_mul_f32 v55, v20, v103
  v_mfma_f32_32x32x16_bf16 v[72:87], a[188:191], v[220:223], v[72:87]
  v_add_f32 v40, 1.0, v40
  v_add_f32 v41, 1.0, v41
  ds_read_b128 a[184:187], v34 offset:22528
  ds_read_b128 a[188:191], v34 offset:23552
  s_waitcnt lgkmcnt(6)
  v_mfma_f32_32x32x16_bf16 v[72:87], a[160:163], v[160:163], v[72:87]
  global_load_dwordx4 a[60:63], v24, s[6:7] offset:3072
  v_add_u32 v24, 0x1000, v24
  v_add_f32 v42, 1.0, v42
  v_mfma_f32_32x32x16_bf16 v[72:87], a[164:167], v[224:227], v[72:87]
  v_add_f32 v43, 1.0, v43
  v_add_f32 v44, 1.0, v44
  ds_read_b128 a[160:163], v35 offset:16384
  ds_read_b128 a[164:167], v35 offset:17408
  s_waitcnt lgkmcnt(6)
  v_mfma_f32_32x32x16_bf16 v[72:87], a[168:171], v[164:167], v[72:87]
  v_add_f32 v45, 1.0, v45
  v_add_f32 v46, 1.0, v46
  v_mfma_f32_32x32x16_bf16 v[72:87], a[172:175], v[228:231], v[72:87]
  global_load_dwordx4 a[64:67], v24, s[6:7] offset:0
  v_add_f32 v47, 1.0, v47
  ds_read_b128 a[168:171], v35 offset:18432
  ds_read_b128 a[172:175], v35 offset:19456
  s_waitcnt lgkmcnt(6)
  v_mfma_f32_32x32x16_bf16 v[72:87], a[176:179], v[168:171], v[72:87]
  v_rcp_f32 v40, v40
  v_rcp_f32 v41, v41
  v_mfma_f32_32x32x16_bf16 v[72:87], a[180:183], v[232:235], v[72:87]
  v_rcp_f32 v42, v42
  v_rcp_f32 v43, v43
  ds_read_b128 a[176:179], v35 offset:20480
  ds_read_b128 a[180:183], v35 offset:21504
  s_waitcnt lgkmcnt(6)
  s_add_u32 m0, s21, 36864
  v_mfma_f32_32x32x16_bf16 v[72:87], a[184:187], v[172:175], v[72:87]
  global_load_lds_dwordx4 v25, s[6:7]
  global_load_lds_dwordx4 v25, s[6:7] offset:1024
  v_add_u32 v25, 0x8000, v25
  v_rcp_f32 v44, v44
  v_mfma_f32_32x32x16_bf16 v[72:87], a[188:191], v[236:239], v[72:87]
  v_rcp_f32 v45, v45
  v_rcp_f32 v46, v46
  ds_read_b128 a[184:187], v35 offset:22528
  ds_read_b128 a[188:191], v35 offset:23552
  s_waitcnt lgkmcnt(6)
  v_mfma_f32_32x32x16_bf16 v[72:87], a[160:163], v[176:179], v[72:87]
  v_rcp_f32 v47, v47
  v_mul_f32 v40, v40, v48
  v_mfma_f32_32x32x16_bf16 v[72:87], a[164:167], v[240:243], v[72:87]
  v_mul_f32 v41, v41, v49
  global_load_dwordx4 a[68:71], v24, s[6:7] offset:1024
  ds_read_b128 a[160:163], v32 offset:8192
  ds_read_b128 a[164:167], v32 offset:9216
  s_waitcnt lgkmcnt(6)
  v_mfma_f32_32x32x16_bf16 v[72:87], a[168:171], v[180:183], v[72:87]
  v_mul_f32 v42, v42, v50
  v_mul_f32 v43, v43, v51
  v_mfma_f32_32x32x16_bf16 v[72:87], a[172:175], v[244:247], v[72:87]
  v_mul_f32 v44, v44, v52
  v_mul_f32 v45, v45, v53
  ds_read_b128 a[168:171], v32 offset:10240
  ds_read_b128 a[172:175], v32 offset:11264
  s_waitcnt lgkmcnt(6)
  v_mfma_f32_32x32x16_bf16 v[72:87], a[176:179], v[184:187], v[72:87]
  s_add_u32 m0, s21, 38912
  v_mul_f32 v46, v46, v54
  global_load_lds_dwordx4 v26, s[6:7]
  global_load_lds_dwordx4 v26, s[6:7] offset:1024
  v_add_u32 v26, 0x8000, v26
  v_mfma_f32_32x32x16_bf16 v[72:87], a[180:183], v[248:251], v[72:87]
  v_mul_f32 v47, v47, v55
  v_cvt_pk_bf16_f32 v56, v40, v41
  ds_read_b128 a[176:179], v32 offset:12288
  ds_read_b128 a[180:183], v32 offset:13312
  s_waitcnt lgkmcnt(6)
  v_mfma_f32_32x32x16_bf16 v[72:87], a[184:187], v[188:191], v[72:87]
  v_cvt_pk_bf16_f32 v57, v42, v43
  v_cvt_pk_bf16_f32 v58, v44, v45
  v_mfma_f32_32x32x16_bf16 v[72:87], a[188:191], v[252:255], v[72:87]
  v_cvt_pk_bf16_f32 v59, v46, v47
  global_store_dwordx4 v11, v[56:59], s[40:41] sc1
  ds_read_b128 a[184:187], v32 offset:14336
  ds_read_b128 a[188:191], v32 offset:15360
  s_waitcnt lgkmcnt(6)
  v_mfma_f32_32x32x16_bf16 v[88:103], a[160:163], v[128:131], 0
  global_load_dwordx4 a[72:75], v24, s[6:7] offset:2048
  s_lshl_b32 s44, s16, 10
  s_add_u32 s44, s44, 16793600
  s_add_u32 s40, s6, s44
  s_addc_u32 s41, s7, 0
  v_mfma_f32_32x32x16_bf16 v[88:103], a[164:167], v[192:195], v[88:103]
  v_mul_f32 v40, v21, v72
  v_mul_f32 v41, v21, v73
  ds_read_b128 a[160:163], v33 offset:8192
  ds_read_b128 a[164:167], v33 offset:9216
  s_waitcnt lgkmcnt(6)
  v_mfma_f32_32x32x16_bf16 v[88:103], a[168:171], v[132:135], v[88:103]
  v_mul_f32 v42, v21, v74
  v_mul_f32 v43, v21, v75
  v_mfma_f32_32x32x16_bf16 v[88:103], a[172:175], v[196:199], v[88:103]
  v_mul_f32 v44, v21, v76
  v_mul_f32 v45, v21, v77
  ds_read_b128 a[168:171], v33 offset:10240
  ds_read_b128 a[172:175], v33 offset:11264
  s_waitcnt lgkmcnt(6)
  v_mfma_f32_32x32x16_bf16 v[88:103], a[176:179], v[136:139], v[88:103]
  v_mul_f32 v46, v21, v78
  v_mul_f32 v47, v21, v79
  v_mfma_f32_32x32x16_bf16 v[88:103], a[180:183], v[200:203], v[88:103]
  global_load_dwordx4 a[76:79], v24, s[6:7] offset:3072
  v_add_u32 v24, 0x1000, v24
  v_exp_f32 v40, v40
  ds_read_b128 a[176:179], v33 offset:12288
  ds_read_b128 a[180:183], v33 offset:13312
  s_waitcnt lgkmcnt(6)
  v_mfma_f32_32x32x16_bf16 v[88:103], a[184:187], v[140:143], v[88:103]
  v_mul_f32 v48, v20, v80
  v_exp_f32 v41, v41
  v_mfma_f32_32x32x16_bf16 v[88:103], a[188:191], v[204:207], v[88:103]
  v_mul_f32 v49, v20, v81
  v_exp_f32 v42, v42
  ds_read_b128 a[184:187], v33 offset:14336
  ds_read_b128 a[188:191], v33 offset:15360
  s_waitcnt lgkmcnt(6)
  v_mfma_f32_32x32x16_bf16 v[88:103], a[160:163], v[144:147], v[88:103]
  v_mul_f32 v50, v20, v82
  v_exp_f32 v43, v43
  v_mfma_f32_32x32x16_bf16 v[88:103], a[164:167], v[208:211], v[88:103]
  v_mul_f32 v51, v20, v83
  v_exp_f32 v44, v44
  ds_read_b128 a[160:163], v34 offset:8192
  ds_read_b128 a[164:167], v34 offset:9216
  s_waitcnt lgkmcnt(6)
  v_mfma_f32_32x32x16_bf16 v[88:103], a[168:171], v[148:151], v[88:103]
  global_load_dwordx4 a[80:83], v24, s[6:7] offset:0
  v_mul_f32 v52, v20, v84
  v_mfma_f32_32x32x16_bf16 v[88:103], a[172:175], v[212:215], v[88:103]
  v_exp_f32 v45, v45
  v_mul_f32 v53, v20, v85
  ds_read_b128 a[168:171], v34 offset:10240
  ds_read_b128 a[172:175], v34 offset:11264
  s_waitcnt lgkmcnt(6)
  v_mfma_f32_32x32x16_bf16 v[88:103], a[176:179], v[152:155], v[88:103]
  v_exp_f32 v46, v46
  v_mul_f32 v54, v20, v86
  v_mfma_f32_32x32x16_bf16 v[88:103], a[180:183], v[216:219], v[88:103]
  v_exp_f32 v47, v47
  v_mul_f32 v55, v20, v87
  ds_read_b128 a[176:179], v34 offset:12288
  ds_read_b128 a[180:183], v34 offset:13312
  s_waitcnt lgkmcnt(6)
  v_mfma_f32_32x32x16_bf16 v[88:103], a[184:187], v[156:159], v[88:103]
  v_add_f32 v40, 1.0, v40
  v_add_f32 v41, 1.0, v41
  v_mfma_f32_32x32x16_bf16 v[88:103], a[188:191], v[220:223], v[88:103]
  s_waitcnt vmcnt(3)
  ds_read_b128 a[184:187], v34 offset:14336
  ds_read_b128 a[188:191], v34 offset:15360
  s_waitcnt lgkmcnt(6)
  v_mfma_f32_32x32x16_bf16 v[88:103], a[160:163], v[160:163], v[88:103]
  s_lshl_b32 s22, s15, 10
  s_lshl_b32 s23, s16, 4
  s_add_u32 s22, s22, s23
  s_lshl_b32 s23, s14, 2
  s_add_u32 s22, s22, s23
  s_add_u32 s22, s22, 2228224
  v_mov_b32 v27, s22
  v_mov_b32 v28, 1
  s_mov_b64 s[36:37], exec
  s_mov_b64 exec, 1
  global_store_dword v27, v28, s[6:7] sc1
  s_mov_b64 exec, s[36:37]
  global_load_dwordx4 a[84:87], v24, s[6:7] offset:1024
  v_mfma_f32_32x32x16_bf16 v[88:103], a[164:167], v[224:227], v[88:103]
  v_add_f32 v42, 1.0, v42
  v_add_f32 v43, 1.0, v43
  ds_read_b128 a[160:163], v35 offset:8192
  ds_read_b128 a[164:167], v35 offset:9216
  s_waitcnt lgkmcnt(6)
  v_mfma_f32_32x32x16_bf16 v[88:103], a[168:171], v[164:167], v[88:103]
  v_add_f32 v44, 1.0, v44
  v_add_f32 v45, 1.0, v45
  v_mfma_f32_32x32x16_bf16 v[88:103], a[172:175], v[228:231], v[88:103]
  v_add_f32 v46, 1.0, v46
  v_add_f32 v47, 1.0, v47
  ds_read_b128 a[168:171], v35 offset:10240
  ds_read_b128 a[172:175], v35 offset:11264
  s_waitcnt lgkmcnt(6)
  v_mfma_f32_32x32x16_bf16 v[88:103], a[176:179], v[168:171], v[88:103]
  v_rcp_f32 v40, v40
  v_rcp_f32 v41, v41
  v_mfma_f32_32x32x16_bf16 v[88:103], a[180:183], v[232:235], v[88:103]
  v_rcp_f32 v42, v42
  global_load_dwordx4 a[88:91], v24, s[6:7] offset:2048
  ds_read_b128 a[176:179], v35 offset:12288
  ds_read_b128 a[180:183], v35 offset:13312
  s_waitcnt lgkmcnt(6)
  v_mfma_f32_32x32x16_bf16 v[88:103], a[184:187], v[172:175], v[88:103]
  v_rcp_f32 v43, v43
  v_rcp_f32 v44, v44
  v_mfma_f32_32x32x16_bf16 v[88:103], a[188:191], v[236:239], v[88:103]
  v_rcp_f32 v45, v45
  v_rcp_f32 v46, v46
  ds_read_b128 a[184:187], v35 offset:14336
  ds_read_b128 a[188:191], v35 offset:15360
  s_waitcnt lgkmcnt(6)
  v_mfma_f32_32x32x16_bf16 v[88:103], a[160:163], v[176:179], v[88:103]
  v_rcp_f32 v47, v47
  v_mul_f32 v40, v40, v48
  v_mfma_f32_32x32x16_bf16 v[88:103], a[164:167], v[240:243], v[88:103]
  v_mul_f32 v41, v41, v49
  v_mul_f32 v42, v42, v50
  s_waitcnt lgkmcnt(4)
  v_mfma_f32_32x32x16_bf16 v[88:103], a[168:171], v[180:183], v[88:103]
  v_mul_f32 v43, v43, v51
  global_load_dwordx4 a[92:95], v24, s[6:7] offset:3072
  v_add_u32 v24, 0x1000, v24
  v_mfma_f32_32x32x16_bf16 v[88:103], a[172:175], v[244:247], v[88:103]
  v_mul_f32 v44, v44, v52
  v_mul_f32 v45, v45, v53
  s_waitcnt lgkmcnt(2)
  v_mfma_f32_32x32x16_bf16 v[88:103], a[176:179], v[184:187], v[88:103]
  v_mul_f32 v46, v46, v54
  v_mul_f32 v47, v47, v55
  v_mfma_f32_32x32x16_bf16 v[88:103], a[180:183], v[248:251], v[88:103]
  v_cvt_pk_bf16_f32 v56, v40, v41
  v_cvt_pk_bf16_f32 v57, v42, v43
  s_waitcnt lgkmcnt(0)
  v_mfma_f32_32x32x16_bf16 v[88:103], a[184:187], v[188:191], v[88:103]
  v_cvt_pk_bf16_f32 v58, v44, v45
  v_cvt_pk_bf16_f32 v59, v46, v47
  v_mfma_f32_32x32x16_bf16 v[88:103], a[188:191], v[252:255], v[88:103]
  global_store_dwordx4 v11, v[56:59], s[40:41] sc1
  s_waitcnt vmcnt(9)
  s_barrier
  ds_read_b128 a[160:163], v32 offset:24576
  ds_read_b128 a[164:167], v32 offset:25600
  ds_read_b128 a[168:171], v32 offset:26624
  ds_read_b128 a[172:175], v32 offset:27648
  ds_read_b128 a[176:179], v32 offset:28672
  ds_read_b128 a[180:183], v32 offset:29696
  ds_read_b128 a[184:187], v32 offset:30720
  ds_read_b128 a[188:191], v32 offset:31744
  s_waitcnt lgkmcnt(6)
  v_mfma_f32_32x32x16_bf16 v[72:87], a[160:163], v[128:131], 0
  global_load_dwordx4 a[96:99], v24, s[6:7] offset:0
  s_lshl_b32 s44, s16, 10
  s_add_u32 s44, s44, 16794112
  s_add_u32 s40, s6, s44
  s_addc_u32 s41, s7, 0
  v_mfma_f32_32x32x16_bf16 v[72:87], a[164:167], v[192:195], v[72:87]
  v_mul_f32 v40, v21, v88
  v_mul_f32 v41, v21, v89
  ds_read_b128 a[160:163], v33 offset:24576
  ds_read_b128 a[164:167], v33 offset:25600
  s_waitcnt lgkmcnt(6)
  v_mfma_f32_32x32x16_bf16 v[72:87], a[168:171], v[132:135], v[72:87]
  v_mul_f32 v42, v21, v90
  v_mul_f32 v43, v21, v91
  v_mfma_f32_32x32x16_bf16 v[72:87], a[172:175], v[196:199], v[72:87]
  global_load_dwordx4 a[100:103], v24, s[6:7] offset:1024
  v_mul_f32 v44, v21, v92
  ds_read_b128 a[168:171], v33 offset:26624
  ds_read_b128 a[172:175], v33 offset:27648
  s_waitcnt lgkmcnt(6)
  v_mfma_f32_32x32x16_bf16 v[72:87], a[176:179], v[136:139], v[72:87]
  v_mul_f32 v45, v21, v93
  v_mul_f32 v46, v21, v94
  v_mfma_f32_32x32x16_bf16 v[72:87], a[180:183], v[200:203], v[72:87]
  v_mul_f32 v47, v21, v95
  v_exp_f32 v40, v40
  ds_read_b128 a[176:179], v33 offset:28672
  ds_read_b128 a[180:183], v33 offset:29696
  s_waitcnt lgkmcnt(6)
  s_add_u32 m0, s21, 0
  v_mfma_f32_32x32x16_bf16 v[72:87], a[184:187], v[140:143], v[72:87]
  global_load_lds_dwordx4 v8, s[6:7]
  global_load_lds_dwordx4 v8, s[6:7] offset:1024
  v_add_u32 v8, 0x8000, v8
  v_mul_f32 v48, v20, v96
  v_mfma_f32_32x32x16_bf16 v[72:87], a[188:191], v[204:207], v[72:87]
  v_exp_f32 v41, v41
  v_mul_f32 v49, v20, v97
  ds_read_b128 a[184:187], v33 offset:30720
  ds_read_b128 a[188:191], v33 offset:31744
  s_waitcnt lgkmcnt(6)
  v_mfma_f32_32x32x16_bf16 v[72:87], a[160:163], v[144:147], v[72:87]
  v_exp_f32 v42, v42
  v_mul_f32 v50, v20, v98
  v_mfma_f32_32x32x16_bf16 v[72:87], a[164:167], v[208:211], v[72:87]
  v_exp_f32 v43, v43
  global_load_dwordx4 a[104:107], v24, s[6:7] offset:2048
  ds_read_b128 a[160:163], v34 offset:24576
  ds_read_b128 a[164:167], v34 offset:25600
  s_waitcnt lgkmcnt(6)
  v_mfma_f32_32x32x16_bf16 v[72:87], a[168:171], v[148:151], v[72:87]
  v_mul_f32 v51, v20, v99
  v_exp_f32 v44, v44
  v_mfma_f32_32x32x16_bf16 v[72:87], a[172:175], v[212:215], v[72:87]
  v_mul_f32 v52, v20, v100
  v_exp_f32 v45, v45
  ds_read_b128 a[168:171], v34 offset:26624
  ds_read_b128 a[172:175], v34 offset:27648
  s_waitcnt lgkmcnt(6)
  v_mfma_f32_32x32x16_bf16 v[72:87], a[176:179], v[152:155], v[72:87]
  s_add_u32 m0, s21, 2048
  v_mul_f32 v53, v20, v101
  global_load_lds_dwordx4 v9, s[6:7]
  global_load_lds_dwordx4 v9, s[6:7] offset:1024
  v_add_u32 v9, 0x8000, v9
  v_mfma_f32_32x32x16_bf16 v[72:87], a[180:183], v[216:219], v[72:87]
  v_exp_f32 v46, v46
  v_mul_f32 v54, v20, v102
  ds_read_b128 a[176:179], v34 offset:28672
  ds_read_b128 a[180:183], v34 offset:29696
  s_waitcnt lgkmcnt(6)
  v_mfma_f32_32x32x16_bf16 v[72:87], a[184:187], v[156:159], v[72:87]
  v_exp_f32 v47, v47
  v_mul_f32 v55, v20, v103
  v_mfma_f32_32x32x16_bf16 v[72:87], a[188:191], v[220:223], v[72:87]
  v_add_f32 v40, 1.0, v40
  v_add_f32 v41, 1.0, v41
  ds_read_b128 a[184:187], v34 offset:30720
  ds_read_b128 a[188:191], v34 offset:31744
  s_waitcnt lgkmcnt(6)
  v_mfma_f32_32x32x16_bf16 v[72:87], a[160:163], v[160:163], v[72:87]
  global_load_dwordx4 a[108:111], v24, s[6:7] offset:3072
  v_add_u32 v24, 0x1000, v24
  v_add_f32 v42, 1.0, v42
  v_mfma_f32_32x32x16_bf16 v[72:87], a[164:167], v[224:227], v[72:87]
  v_add_f32 v43, 1.0, v43
  v_add_f32 v44, 1.0, v44
  ds_read_b128 a[160:163], v35 offset:24576
  ds_read_b128 a[164:167], v35 offset:25600
  s_waitcnt lgkmcnt(6)
  v_mfma_f32_32x32x16_bf16 v[72:87], a[168:171], v[164:167], v[72:87]
  v_add_f32 v45, 1.0, v45
  v_add_f32 v46, 1.0, v46
  v_mfma_f32_32x32x16_bf16 v[72:87], a[172:175], v[228:231], v[72:87]
  global_load_dwordx4 a[112:115], v24, s[6:7] offset:0
  v_add_f32 v47, 1.0, v47
  ds_read_b128 a[168:171], v35 offset:26624
  ds_read_b128 a[172:175], v35 offset:27648
  s_waitcnt lgkmcnt(6)
  v_mfma_f32_32x32x16_bf16 v[72:87], a[176:179], v[168:171], v[72:87]
  v_rcp_f32 v40, v40
  v_rcp_f32 v41, v41
  v_mfma_f32_32x32x16_bf16 v[72:87], a[180:183], v[232:235], v[72:87]
  v_rcp_f32 v42, v42
  v_rcp_f32 v43, v43
  ds_read_b128 a[176:179], v35 offset:28672
  ds_read_b128 a[180:183], v35 offset:29696
  s_waitcnt lgkmcnt(6)
  s_add_u32 m0, s21, 4096
  v_mfma_f32_32x32x16_bf16 v[72:87], a[184:187], v[172:175], v[72:87]
  global_load_lds_dwordx4 v25, s[6:7]
  global_load_lds_dwordx4 v25, s[6:7] offset:1024
  v_add_u32 v25, 0x8000, v25
  v_rcp_f32 v44, v44
  v_mfma_f32_32x32x16_bf16 v[72:87], a[188:191], v[236:239], v[72:87]
  v_rcp_f32 v45, v45
  v_rcp_f32 v46, v46
  ds_read_b128 a[184:187], v35 offset:30720
  ds_read_b128 a[188:191], v35 offset:31744
  s_waitcnt lgkmcnt(6)
  v_mfma_f32_32x32x16_bf16 v[72:87], a[160:163], v[176:179], v[72:87]
  v_rcp_f32 v47, v47
  v_mul_f32 v40, v40, v48
  v_mfma_f32_32x32x16_bf16 v[72:87], a[164:167], v[240:243], v[72:87]
  v_mul_f32 v41, v41, v49
  global_load_dwordx4 a[116:119], v24, s[6:7] offset:1024
  ds_read_b128 a[160:163], v32 offset:32768
  ds_read_b128 a[164:167], v32 offset:33792
  s_waitcnt lgkmcnt(6)
  v_mfma_f32_32x32x16_bf16 v[72:87], a[168:171], v[180:183], v[72:87]
  v_mul_f32 v42, v42, v50
  v_mul_f32 v43, v43, v51
  v_mfma_f32_32x32x16_bf16 v[72:87], a[172:175], v[244:247], v[72:87]
  v_mul_f32 v44, v44, v52
  v_mul_f32 v45, v45, v53
  ds_read_b128 a[168:171], v32 offset:34816
  ds_read_b128 a[172:175], v32 offset:35840
  s_waitcnt lgkmcnt(6)
  v_mfma_f32_32x32x16_bf16 v[72:87], a[176:179], v[184:187], v[72:87]
  s_add_u32 m0, s21, 6144
  v_mul_f32 v46, v46, v54
  global_load_lds_dwordx4 v26, s[6:7]
  global_load_lds_dwordx4 v26, s[6:7] offset:1024
  v_add_u32 v26, 0x8000, v26
  v_mfma_f32_32x32x16_bf16 v[72:87], a[180:183], v[248:251], v[72:87]
  v_mul_f32 v47, v47, v55
  v_cvt_pk_bf16_f32 v56, v40, v41
  ds_read_b128 a[176:179], v32 offset:36864
  ds_read_b128 a[180:183], v32 offset:37888
  s_waitcnt lgkmcnt(6)
  v_mfma_f32_32x32x16_bf16 v[72:87], a[184:187], v[188:191], v[72:87]
  v_cvt_pk_bf16_f32 v57, v42, v43
  v_cvt_pk_bf16_f32 v58, v44, v45
  v_mfma_f32_32x32x16_bf16 v[72:87], a[188:191], v[252:255], v[72:87]
  v_cvt_pk_bf16_f32 v59, v46, v47
  global_store_dwordx4 v11, v[56:59], s[40:41] sc1
  ds_read_b128 a[184:187], v32 offset:38912
  ds_read_b128 a[188:191], v32 offset:39936
  s_waitcnt lgkmcnt(6)
  v_mfma_f32_32x32x16_bf16 v[88:103], a[160:163], v[128:131], 0
  global_load_dwordx4 a[120:123], v24, s[6:7] offset:2048
  s_lshl_b32 s44, s16, 10
  s_add_u32 s44, s44, 16809984
  s_add_u32 s40, s6, s44
  s_addc_u32 s41, s7, 0
  v_mfma_f32_32x32x16_bf16 v[88:103], a[164:167], v[192:195], v[88:103]
  v_mul_f32 v40, v21, v72
  v_mul_f32 v41, v21, v73
  ds_read_b128 a[160:163], v33 offset:32768
  ds_read_b128 a[164:167], v33 offset:33792
  s_waitcnt lgkmcnt(6)
  v_mfma_f32_32x32x16_bf16 v[88:103], a[168:171], v[132:135], v[88:103]
  v_mul_f32 v42, v21, v74
  v_mul_f32 v43, v21, v75
  v_mfma_f32_32x32x16_bf16 v[88:103], a[172:175], v[196:199], v[88:103]
  v_mul_f32 v44, v21, v76
  v_mul_f32 v45, v21, v77
  ds_read_b128 a[168:171], v33 offset:34816
  ds_read_b128 a[172:175], v33 offset:35840
  s_waitcnt lgkmcnt(6)
  v_mfma_f32_32x32x16_bf16 v[88:103], a[176:179], v[136:139], v[88:103]
  v_mul_f32 v46, v21, v78
  v_mul_f32 v47, v21, v79
  v_mfma_f32_32x32x16_bf16 v[88:103], a[180:183], v[200:203], v[88:103]
  global_load_dwordx4 a[124:127], v24, s[6:7] offset:3072
  v_add_u32 v24, 0x1000, v24
  v_exp_f32 v40, v40
  ds_read_b128 a[176:179], v33 offset:36864
  ds_read_b128 a[180:183], v33 offset:37888
  s_waitcnt lgkmcnt(6)
  v_mfma_f32_32x32x16_bf16 v[88:103], a[184:187], v[140:143], v[88:103]
  v_mul_f32 v48, v20, v80
  v_exp_f32 v41, v41
  v_mfma_f32_32x32x16_bf16 v[88:103], a[188:191], v[204:207], v[88:103]
  v_mul_f32 v49, v20, v81
  v_exp_f32 v42, v42
  ds_read_b128 a[184:187], v33 offset:38912
  ds_read_b128 a[188:191], v33 offset:39936
  s_waitcnt lgkmcnt(6)
  v_mfma_f32_32x32x16_bf16 v[88:103], a[160:163], v[144:147], v[88:103]
  v_mul_f32 v50, v20, v82
  v_exp_f32 v43, v43
  v_mfma_f32_32x32x16_bf16 v[88:103], a[164:167], v[208:211], v[88:103]
  s_lshl_b32 s22, s15, 10
  s_add_u32 s22, s22, 2228224
  v_lshl_add_u32 v30, v2, 2, s22
  global_load_dword v29, v30, s[6:7] sc1
  v_mul_f32 v51, v20, v83
  ds_read_b128 a[160:163], v34 offset:32768
  ds_read_b128 a[164:167], v34 offset:33792
  s_waitcnt lgkmcnt(6)
  v_mfma_f32_32x32x16_bf16 v[88:103], a[168:171], v[148:151], v[88:103]
  v_exp_f32 v44, v44
  global_load_dwordx4 a[128:131], v24, s[6:7] offset:0
  v_mfma_f32_32x32x16_bf16 v[88:103], a[172:175], v[212:215], v[88:103]
  v_mul_f32 v52, v20, v84
  v_exp_f32 v45, v45
  ds_read_b128 a[168:171], v34 offset:34816
  ds_read_b128 a[172:175], v34 offset:35840
  s_waitcnt lgkmcnt(6)
  v_mfma_f32_32x32x16_bf16 v[88:103], a[176:179], v[152:155], v[88:103]
  v_mul_f32 v53, v20, v85
  v_exp_f32 v46, v46
  v_mfma_f32_32x32x16_bf16 v[88:103], a[180:183], v[216:219], v[88:103]
  v_mul_f32 v54, v20, v86
  v_exp_f32 v47, v47
  ds_read_b128 a[176:179], v34 offset:36864
  ds_read_b128 a[180:183], v34 offset:37888
  s_waitcnt lgkmcnt(6)
  v_mfma_f32_32x32x16_bf16 v[88:103], a[184:187], v[156:159], v[88:103]
  v_mul_f32 v55, v20, v87
  v_add_f32 v40, 1.0, v40
  v_mfma_f32_32x32x16_bf16 v[88:103], a[188:191], v[220:223], v[88:103]
  v_add_f32 v41, 1.0, v41
  s_waitcnt vmcnt(4)
  ds_read_b128 a[184:187], v34 offset:38912
  ds_read_b128 a[188:191], v34 offset:39936
  s_waitcnt lgkmcnt(6)
  v_mfma_f32_32x32x16_bf16 v[88:103], a[160:163], v[160:163], v[88:103]
  s_lshl_b32 s22, s15, 10
  s_lshl_b32 s23, s16, 4
  s_add_u32 s22, s22, s23
  s_lshl_b32 s23, s14, 2
  s_add_u32 s22, s22, s23
  s_add_u32 s22, s22, 2228480
  v_mov_b32 v27, s22
  v_mov_b32 v28, 1
  s_mov_b64 s[36:37], exec
  s_mov_b64 exec, 1
  global_store_dword v27, v28, s[6:7] sc1
  s_mov_b64 exec, s[36:37]
  global_load_dwordx4 a[132:135], v24, s[6:7] offset:1024
  v_mfma_f32_32x32x16_bf16 v[88:103], a[164:167], v[224:227], v[88:103]
  v_add_f32 v42, 1.0, v42
  v_add_f32 v43, 1.0, v43
  ds_read_b128 a[160:163], v35 offset:32768
  ds_read_b128 a[164:167], v35 offset:33792
  s_waitcnt lgkmcnt(6)
  v_mfma_f32_32x32x16_bf16 v[88:103], a[168:171], v[164:167], v[88:103]
  v_add_f32 v44, 1.0, v44
  v_add_f32 v45, 1.0, v45
  v_mfma_f32_32x32x16_bf16 v[88:103], a[172:175], v[228:231], v[88:103]
  v_add_f32 v46, 1.0, v46
  v_add_f32 v47, 1.0, v47
  ds_read_b128 a[168:171], v35 offset:34816
  ds_read_b128 a[172:175], v35 offset:35840
  s_waitcnt lgkmcnt(6)
  v_mfma_f32_32x32x16_bf16 v[88:103], a[176:179], v[168:171], v[88:103]
  v_rcp_f32 v40, v40
  v_rcp_f32 v41, v41
  v_mfma_f32_32x32x16_bf16 v[88:103], a[180:183], v[232:235], v[88:103]
  v_rcp_f32 v42, v42
  global_load_dwordx4 a[136:139], v24, s[6:7] offset:2048
  ds_read_b128 a[176:179], v35 offset:36864
  ds_read_b128 a[180:183], v35 offset:37888
  s_waitcnt lgkmcnt(6)
  v_mfma_f32_32x32x16_bf16 v[88:103], a[184:187], v[172:175], v[88:103]
  v_rcp_f32 v43, v43
  v_rcp_f32 v44, v44
  v_mfma_f32_32x32x16_bf16 v[88:103], a[188:191], v[236:239], v[88:103]
  v_rcp_f32 v45, v45
  v_rcp_f32 v46, v46
  ds_read_b128 a[184:187], v35 offset:38912
  ds_read_b128 a[188:191], v35 offset:39936
  s_waitcnt lgkmcnt(6)
  v_mfma_f32_32x32x16_bf16 v[88:103], a[160:163], v[176:179], v[88:103]
  v_rcp_f32 v47, v47
  v_mul_f32 v40, v40, v48
  v_mfma_f32_32x32x16_bf16 v[88:103], a[164:167], v[240:243], v[88:103]
  v_mul_f32 v41, v41, v49
  v_mul_f32 v42, v42, v50
  s_waitcnt lgkmcnt(4)
  v_mfma_f32_32x32x16_bf16 v[88:103], a[168:171], v[180:183], v[88:103]
  v_mul_f32 v43, v43, v51
  global_load_dwordx4 a[140:143], v24, s[6:7] offset:3072
  v_add_u32 v24, 0x1000, v24
  v_mfma_f32_32x32x16_bf16 v[88:103], a[172:175], v[244:247], v[88:103]
  v_mul_f32 v44, v44, v52
  v_mul_f32 v45, v45, v53
  s_waitcnt lgkmcnt(2)
  v_mfma_f32_32x32x16_bf16 v[88:103], a[176:179], v[184:187], v[88:103]
  v_mul_f32 v46, v46, v54
  v_mul_f32 v47, v47, v55
  v_mfma_f32_32x32x16_bf16 v[88:103], a[180:183], v[248:251], v[88:103]
  v_cvt_pk_bf16_f32 v56, v40, v41
  v_cvt_pk_bf16_f32 v57, v42, v43
  s_waitcnt lgkmcnt(0)
  v_mfma_f32_32x32x16_bf16 v[88:103], a[184:187], v[188:191], v[88:103]
  v_cvt_pk_bf16_f32 v58, v44, v45
  v_cvt_pk_bf16_f32 v59, v46, v47
  v_mfma_f32_32x32x16_bf16 v[88:103], a[188:191], v[252:255], v[88:103]
  global_store_dwordx4 v11, v[56:59], s[40:41] sc1
  s_waitcnt vmcnt(10)
  s_barrier
  ds_read_b128 a[160:163], v32 offset:0
  ds_read_b128 a[164:167], v32 offset:1024
  ds_read_b128 a[168:171], v32 offset:2048
  ds_read_b128 a[172:175], v32 offset:3072
  ds_read_b128 a[176:179], v32 offset:4096
  ds_read_b128 a[180:183], v32 offset:5120
  ds_read_b128 a[184:187], v32 offset:6144
  ds_read_b128 a[188:191], v32 offset:7168
  s_waitcnt lgkmcnt(6)
  v_mfma_f32_32x32x16_bf16 v[72:87], a[160:163], v[128:131], 0
  s_waitcnt vmcnt(6)
  v_cmp_eq_u32 vcc, 1, v29
  s_nop 0
  s_cmp_eq_u64 vcc, exec
  s_cbranch_scc1 KD_readyA
  s_mov_b32 s23, 0
KD_pollA:
  global_load_dword v29, v30, s[6:7] sc1
  s_waitcnt vmcnt(0)
  v_cmp_eq_u32 vcc, 1, v29
  s_add_u32 s23, s23, 1
  s_cmp_eq_u64 vcc, exec
  s_cbranch_scc1 KD_readyA
  s_cmp_lt_u32 s23, 0x20000
  s_cbranch_scc1 KD_pollA
KD_readyA:
  s_add_u32 m0, s21, 16384
  s_nop 0
  global_load_lds_dwordx4 v7, s[6:7] offset:0 sc1
  global_load_lds_dwordx4 v7, s[6:7] offset:1024 sc1
  v_mfma_f32_32x32x16_bf16 v[72:87], a[164:167], v[192:195], v[72:87]
  global_load_dwordx4 a[144:147], v24, s[6:7] offset:0
  s_lshl_b32 s44, s16, 10
  s_add_u32 s44, s44, 16810496
  s_add_u32 s40, s6, s44
  s_addc_u32 s41, s7, 0
  ds_read_b128 a[160:163], v33 offset:0
  ds_read_b128 a[164:167], v33 offset:1024
  s_waitcnt lgkmcnt(6)
  v_mfma_f32_32x32x16_bf16 v[72:87], a[168:171], v[132:135], v[72:87]
  v_mul_f32 v40, v21, v88
  v_mul_f32 v41, v21, v89
  v_mfma_f32_32x32x16_bf16 v[72:87], a[172:175], v[196:199], v[72:87]
  v_mul_f32 v42, v21, v90
  v_mul_f32 v43, v21, v91
  ds_read_b128 a[168:171], v33 offset:2048
  ds_read_b128 a[172:175], v33 offset:3072
  s_waitcnt lgkmcnt(6)
  v_mfma_f32_32x32x16_bf16 v[72:87], a[176:179], v[136:139], v[72:87]
  s_add_u32 m0, s21, 16384
  v_mul_f32 v44, v21, v92
  global_load_lds_dwordx4 v7, s[6:7] offset:2048 sc1
  global_load_lds_dwordx4 v7, s[6:7] offset:3072 sc1
  v_mfma_f32_32x32x16_bf16 v[72:87], a[180:183], v[200:203], v[72:87]
  v_mul_f32 v45, v21, v93
  v_mul_f32 v46, v21, v94
  ds_read_b128 a[176:179], v33 offset:4096
  ds_read_b128 a[180:183], v33 offset:5120
  s_waitcnt lgkmcnt(6)
  v_mfma_f32_32x32x16_bf16 v[72:87], a[184:187], v[140:143], v[72:87]
  v_mul_f32 v47, v21, v95
  v_exp_f32 v40, v40
  v_mul_f32 v48, v20, v96
  v_mfma_f32_32x32x16_bf16 v[72:87], a[188:191], v[204:207], v[72:87]
  v_exp_f32 v41, v41
  v_mul_f32 v49, v20, v97
  ds_read_b128 a[184:187], v33 offset:6144
  ds_read_b128 a[188:191], v33 offset:7168
  s_waitcnt lgkmcnt(6)
  s_add_u32 m0, s21, 20480
  v_mfma_f32_32x32x16_bf16 v[72:87], a[160:163], v[144:147], v[72:87]
  global_load_lds_dwordx4 v7, s[24:25] offset:0 sc1
  global_load_lds_dwordx4 v7, s[24:25] offset:1024 sc1
  global_load_dwordx4 a[148:151], v24, s[6:7] offset:1024
  v_mfma_f32_32x32x16_bf16 v[72:87], a[164:167], v[208:211], v[72:87]
  v_exp_f32 v42, v42
  v_mul_f32 v50, v20, v98
  ds_read_b128 a[160:163], v34 offset:0
  ds_read_b128 a[164:167], v34 offset:1024
  s_waitcnt lgkmcnt(6)
  v_mfma_f32_32x32x16_bf16 v[72:87], a[168:171], v[148:151], v[72:87]
  v_exp_f32 v43, v43
  v_mul_f32 v51, v20, v99
  v_mfma_f32_32x32x16_bf16 v[72:87], a[172:175], v[212:215], v[72:87]
  v_exp_f32 v44, v44
  v_mul_f32 v52, v20, v100
  ds_read_b128 a[168:171], v34 offset:2048
  ds_read_b128 a[172:175], v34 offset:3072
  s_waitcnt lgkmcnt(6)
  s_add_u32 m0, s21, 20480
  v_mfma_f32_32x32x16_bf16 v[72:87], a[176:179], v[152:155], v[72:87]
  global_load_lds_dwordx4 v7, s[24:25] offset:2048 sc1
  global_load_lds_dwordx4 v7, s[24:25] offset:3072 sc1
  v_add_u32 v7, 0x2000, v7
  v_exp_f32 v45, v45
  v_mul_f32 v53, v20, v101
  v_mfma_f32_32x32x16_bf16 v[72:87], a[180:183], v[216:219], v[72:87]
  v_exp_f32 v46, v46
  v_mul_f32 v54, v20, v102
  ds_read_b128 a[176:179], v34 offset:4096
  ds_read_b128 a[180:183], v34 offset:5120
  s_waitcnt lgkmcnt(6)
  v_mfma_f32_32x32x16_bf16 v[72:87], a[184:187], v[156:159], v[72:87]
  v_exp_f32 v47, v47
  v_mul_f32 v55, v20, v103
  v_mfma_f32_32x32x16_bf16 v[72:87], a[188:191], v[220:223], v[72:87]
  v_add_f32 v40, 1.0, v40
  v_add_f32 v41, 1.0, v41
  ds_read_b128 a[184:187], v34 offset:6144
  ds_read_b128 a[188:191], v34 offset:7168
  s_waitcnt lgkmcnt(6)
  s_add_u32 m0, s21, 8192
  v_mfma_f32_32x32x16_bf16 v[72:87], a[160:163], v[160:163], v[72:87]
  global_load_lds_dwordx4 v7, s[6:7] offset:0 sc1
  global_load_lds_dwordx4 v7, s[6:7] offset:1024 sc1
  global_load_dwordx4 a[152:155], v24, s[6:7] offset:2048
  v_mfma_f32_32x32x16_bf16 v[72:87], a[164:167], v[224:227], v[72:87]
  v_add_f32 v42, 1.0, v42
  v_add_f32 v43, 1.0, v43
  ds_read_b128 a[160:163], v35 offset:0
  ds_read_b128 a[164:167], v35 offset:1024
  s_waitcnt lgkmcnt(6)
  v_mfma_f32_32x32x16_bf16 v[72:87], a[168:171], v[164:167], v[72:87]
  v_add_f32 v44, 1.0, v44
  v_add_f32 v45, 1.0, v45
  v_mfma_f32_32x32x16_bf16 v[72:87], a[172:175], v[228:231], v[72:87]
  s_lshl_b32 s22, s15, 10
  s_add_u32 s22, s22, 2228480
  v_lshl_add_u32 v30, v2, 2, s22
  global_load_dword v29, v30, s[6:7] sc1
  v_add_f32 v46, 1.0, v46
  v_add_f32 v47, 1.0, v47
  ds_read_b128 a[168:171], v35 offset:2048
  ds_read_b128 a[172:175], v35 offset:3072
  s_waitcnt lgkmcnt(6)
  s_add_u32 m0, s21, 8192
  v_mfma_f32_32x32x16_bf16 v[72:87], a[176:179], v[168:171], v[72:87]
  global_load_lds_dwordx4 v7, s[6:7] offset:2048 sc1
  global_load_lds_dwordx4 v7, s[6:7] offset:3072 sc1
  v_rcp_f32 v40, v40
  v_mfma_f32_32x32x16_bf16 v[72:87], a[180:183], v[232:235], v[72:87]
  v_rcp_f32 v41, v41
  v_rcp_f32 v42, v42
  ds_read_b128 a[176:179], v35 offset:4096
  ds_read_b128 a[180:183], v35 offset:5120
  s_waitcnt lgkmcnt(6)
  v_mfma_f32_32x32x16_bf16 v[72:87], a[184:187], v[172:175], v[72:87]
  v_rcp_f32 v43, v43
  v_rcp_f32 v44, v44
  v_mfma_f32_32x32x16_bf16 v[72:87], a[188:191], v[236:239], v[72:87]
  v_rcp_f32 v45, v45
  v_rcp_f32 v46, v46
  ds_read_b128 a[184:187], v35 offset:6144
  ds_read_b128 a[188:191], v35 offset:7168
  s_waitcnt lgkmcnt(6)
  s_add_u32 m0, s21, 12288
  v_mfma_f32_32x32x16_bf16 v[72:87], a[160:163], v[176:179], v[72:87]
  global_load_lds_dwordx4 v7, s[24:25] offset:0 sc1
  global_load_lds_dwordx4 v7, s[24:25] offset:1024 sc1
  global_load_dwordx4 a[156:159], v24, s[6:7] offset:3072
  v_add_u32 v24, 0x1000, v24
  v_mfma_f32_32x32x16_bf16 v[72:87], a[164:167], v[240:243], v[72:87]
  v_rcp_f32 v47, v47
  v_mul_f32 v40, v40, v48
  v_mul_f32 v41, v41, v49
  s_waitcnt lgkmcnt(4)
  v_mfma_f32_32x32x16_bf16 v[72:87], a[168:171], v[180:183], v[72:87]
  v_mul_f32 v42, v42, v50
  v_mul_f32 v43, v43, v51
  v_mfma_f32_32x32x16_bf16 v[72:87], a[172:175], v[244:247], v[72:87]
  s_add_u32 m0, s21, 12288
  v_mul_f32 v44, v44, v52
  global_load_lds_dwordx4 v7, s[24:25] offset:2048 sc1
  global_load_lds_dwordx4 v7, s[24:25] offset:3072 sc1
  v_add_u32 v7, 0x2000, v7
  s_waitcnt lgkmcnt(2)
  v_mfma_f32_32x32x16_bf16 v[72:87], a[176:179], v[184:187], v[72:87]
  v_mul_f32 v45, v45, v53
  v_mul_f32 v46, v46, v54
  v_mfma_f32_32x32x16_bf16 v[72:87], a[180:183], v[248:251], v[72:87]
  v_mul_f32 v47, v47, v55
  v_cvt_pk_bf16_f32 v56, v40, v41
  s_waitcnt lgkmcnt(0)
  v_mfma_f32_32x32x16_bf16 v[72:87], a[184:187], v[188:191], v[72:87]
  v_cvt_pk_bf16_f32 v57, v42, v43
  v_cvt_pk_bf16_f32 v58, v44, v45
  v_mfma_f32_32x32x16_bf16 v[72:87], a[188:191], v[252:255], v[72:87]
  v_cvt_pk_bf16_f32 v59, v46, v47
  global_store_dwordx4 v11, v[56:59], s[40:41] sc1
  s_lshl_b32 s44, s16, 9
  s_add_u32 s44, s44, 16826368
  s_add_u32 s40, s6, s44
  s_addc_u32 s41, s7, 0
  s_nop 5
  v_mul_f32 v40, v21, v72
  v_mul_f32 v41, v21, v73
  v_mul_f32 v42, v21, v74
  v_mul_f32 v43, v21, v75
  v_mul_f32 v44, v21, v76
  v_mul_f32 v45, v21, v77
  v_mul_f32 v46, v21, v78
  v_mul_f32 v47, v21, v79
  v_exp_f32 v40, v40
  v_mul_f32 v48, v20, v80
  v_exp_f32 v41, v41
  v_mul_f32 v49, v20, v81
  v_exp_f32 v42, v42
  v_mul_f32 v50, v20, v82
  v_exp_f32 v43, v43
  v_mul_f32 v51, v20, v83
  v_exp_f32 v44, v44
  v_mul_f32 v52, v20, v84
  v_exp_f32 v45, v45
  v_mul_f32 v53, v20, v85
  v_exp_f32 v46, v46
  v_mul_f32 v54, v20, v86
  v_exp_f32 v47, v47
  v_mul_f32 v55, v20, v87
  v_add_f32 v40, 1.0, v40
  v_add_f32 v41, 1.0, v41
  v_add_f32 v42, 1.0, v42
  v_add_f32 v43, 1.0, v43
  v_add_f32 v44, 1.0, v44
  v_add_f32 v45, 1.0, v45
  v_add_f32 v46, 1.0, v46
  v_add_f32 v47, 1.0, v47
  v_rcp_f32 v40, v40
  v_rcp_f32 v41, v41
  v_rcp_f32 v42, v42
  v_rcp_f32 v43, v43
  v_rcp_f32 v44, v44
  v_rcp_f32 v45, v45
  v_rcp_f32 v46, v46
  v_rcp_f32 v47, v47
  v_mul_f32 v40, v40, v48
  v_mul_f32 v41, v41, v49
  v_mul_f32 v42, v42, v50
  v_mul_f32 v43, v43, v51
  v_mul_f32 v44, v44, v52
  v_mul_f32 v45, v45, v53
  v_mul_f32 v46, v46, v54
  v_mul_f32 v47, v47, v55
  v_cvt_pk_bf16_f32 v56, v40, v41
  v_cvt_pk_bf16_f32 v57, v42, v43
  v_cvt_pk_bf16_f32 v58, v44, v45
  v_cvt_pk_bf16_f32 v59, v46, v47
  global_store_dwordx4 v11, v[56:59], s[40:41] sc1
  s_waitcnt vmcnt(9)
  v_cmp_eq_u32 vcc, 1, v29
  s_nop 0
  s_cmp_eq_u64 vcc, exec
  s_cbranch_scc1 KD_readyB
  s_mov_b32 s23, 0
KD_pollB:
  global_load_dword v29, v30, s[6:7] sc1
  s_waitcnt vmcnt(0)
  v_cmp_eq_u32 vcc, 1, v29
  s_add_u32 s23, s23, 1
  s_cmp_eq_u64 vcc, exec
  s_cbranch_scc1 KD_readyB
  s_cmp_lt_u32 s23, 0x20000
  s_cbranch_scc1 KD_pollB
KD_readyB:
  s_waitcnt vmcnt(4)
  s_barrier
  ds_read_b128 v[128:131], v32 offset:16384
  ds_read_b128 v[132:135], v33 offset:16384
  ds_read_b128 v[136:139], v34 offset:16384
  ds_read_b128 v[140:143], v35 offset:16384
  ds_read_b128 v[144:147], v32 offset:17408
  ds_read_b128 v[148:151], v33 offset:17408
  ds_read_b128 v[152:155], v34 offset:17408
  s_waitcnt lgkmcnt(6)
  s_add_u32 m0, s21, 24576
  v_mfma_f32_16x16x32_bf16 v[160:163], a[0:3], v[128:131], 0
  global_load_lds_dwordx4 v7, s[6:7] offset:0 sc1
  global_load_lds_dwordx4 v7, s[6:7] offset:1024 sc1
  ds_read_b128 v[156:159], v35 offset:17408
  s_waitcnt lgkmcnt(6)
  v_mfma_f32_16x16x32_bf16 v[164:167], a[0:3], v[132:135], 0
  ds_read_b128 v[128:131], v32 offset:18432
  s_waitcnt lgkmcnt(6)
  v_mfma_f32_16x16x32_bf16 v[168:171], a[0:3], v[136:139], 0
  ds_read_b128 v[132:135], v33 offset:18432
  s_waitcnt lgkmcnt(6)
  s_add_u32 m0, s21, 24576
  v_mfma_f32_16x16x32_bf16 v[172:175], a[0:3], v[140:143], 0
  global_load_lds_dwordx4 v7, s[6:7] offset:2048 sc1
  global_load_lds_dwordx4 v7, s[6:7] offset:3072 sc1
  ds_read_b128 v[136:139], v34 offset:18432
  s_waitcnt lgkmcnt(6)
  v_mfma_f32_16x16x32_bf16 v[160:163], a[4:7], v[144:147], v[160:163]
  ds_read_b128 v[140:143], v35 offset:18432
  s_waitcnt lgkmcnt(6)
  v_mfma_f32_16x16x32_bf16 v[164:167], a[4:7], v[148:151], v[164:167]
  ds_read_b128 v[144:147], v32 offset:19456
  s_waitcnt lgkmcnt(6)
  v_mfma_f32_16x16x32_bf16 v[168:171], a[4:7], v[152:155], v[168:171]
  s_waitcnt vmcnt(5)
  ds_read_b128 v[148:151], v33 offset:19456
  s_waitcnt lgkmcnt(6)
  v_mfma_f32_16x16x32_bf16 v[172:175], a[4:7], v[156:159], v[172:175]
  ds_read_b128 v[152:155], v34 offset:19456
  s_waitcnt lgkmcnt(6)
  v_mfma_f32_16x16x32_bf16 v[160:163], a[8:11], v[128:131], v[160:163]
  ds_read_b128 v[156:159], v35 offset:19456
  s_waitcnt lgkmcnt(6)
  v_mfma_f32_16x16x32_bf16 v[164:167], a[8:11], v[132:135], v[164:167]
  s_lshl_b32 s22, s15, 10
  s_lshl_b32 s23, s16, 4
  s_add_u32 s22, s22, s23
  s_lshl_b32 s23, s14, 2
  s_add_u32 s22, s22, s23
  s_add_u32 s22, s22, 2228736
  v_mov_b32 v27, s22
  v_mov_b32 v28, 1
  s_mov_b64 s[36:37], exec
  s_mov_b64 exec, 1
  global_store_dword v27, v28, s[6:7] sc1
  s_mov_b64 exec, s[36:37]
  ds_read_b128 v[128:131], v32 offset:20480
  s_waitcnt lgkmcnt(6)
  v_mfma_f32_16x16x32_bf16 v[168:171], a[8:11], v[136:139], v[168:171]
  ds_read_b128 v[132:135], v33 offset:20480
  s_waitcnt lgkmcnt(6)
  v_mfma_f32_16x16x32_bf16 v[172:175], a[8:11], v[140:143], v[172:175]
  ds_read_b128 v[136:139], v34 offset:20480
  s_waitcnt lgkmcnt(6)
  s_add_u32 m0, s21, 28672
  v_mfma_f32_16x16x32_bf16 v[160:163], a[12:15], v[144:147], v[160:163]
  global_load_lds_dwordx4 v7, s[24:25] offset:0 sc1
  global_load_lds_dwordx4 v7, s[24:25] offset:1024 sc1
  ds_read_b128 v[140:143], v35 offset:20480
  s_waitcnt lgkmcnt(6)
  v_mfma_f32_16x16x32_bf16 v[164:167], a[12:15], v[148:151], v[164:167]
  ds_read_b128 v[144:147], v32 offset:21504
  s_waitcnt lgkmcnt(6)
  v_mfma_f32_16x16x32_bf16 v[168:171], a[12:15], v[152:155], v[168:171]
  ds_read_b128 v[148:151], v33 offset:21504
  s_waitcnt lgkmcnt(6)
  v_mfma_f32_16x16x32_bf16 v[172:175], a[12:15], v[156:159], v[172:175]
  ds_read_b128 v[152:155], v34 offset:21504
  s_waitcnt lgkmcnt(6)
  s_add_u32 m0, s21, 28672
  v_mfma_f32_16x16x32_bf16 v[160:163], a[16:19], v[128:131], v[160:163]
  global_load_lds_dwordx4 v7, s[24:25] offset:2048 sc1
  global_load_lds_dwordx4 v7, s[24:25] offset:3072 sc1
  v_add_u32 v7, 0x2000, v7
  ds_read_b128 v[156:159], v35 offset:21504
  s_waitcnt lgkmcnt(6)
  v_mfma_f32_16x16x32_bf16 v[164:167], a[16:19], v[132:135], v[164:167]
  ds_read_b128 v[128:131], v32 offset:22528
  s_waitcnt lgkmcnt(6)
  v_mfma_f32_16x16x32_bf16 v[168:171], a[16:19], v[136:139], v[168:171]
  ds_read_b128 v[132:135], v33 offset:22528
  s_waitcnt lgkmcnt(6)
  s_add_u32 m0, s21, 32768
  v_mfma_f32_16x16x32_bf16 v[172:175], a[16:19], v[140:143], v[172:175]
  global_load_lds_dwordx4 v7, s[6:7] offset:0 sc1
  global_load_lds_dwordx4 v7, s[6:7] offset:1024 sc1
  ds_read_b128 v[136:139], v34 offset:22528
  s_waitcnt lgkmcnt(6)
  v_mfma_f32_16x16x32_bf16 v[160:163], a[20:23], v[144:147], v[160:163]
  ds_read_b128 v[140:143], v35 offset:22528
  s_waitcnt lgkmcnt(6)
  v_mfma_f32_16x16x32_bf16 v[164:167], a[20:23], v[148:151], v[164:167]
  ds_read_b128 v[144:147], v32 offset:23552
  s_waitcnt lgkmcnt(6)
  s_add_u32 m0, s21, 32768
  v_mfma_f32_16x16x32_bf16 v[168:171], a[20:23], v[152:155], v[168:171]
  global_load_lds_dwordx4 v7, s[6:7] offset:2048 sc1
  global_load_lds_dwordx4 v7, s[6:7] offset:3072 sc1
  ds_read_b128 v[148:151], v33 offset:23552
  s_waitcnt lgkmcnt(6)
  v_mfma_f32_16x16x32_bf16 v[172:175], a[20:23], v[156:159], v[172:175]
  ds_read_b128 v[152:155], v34 offset:23552
  s_waitcnt lgkmcnt(6)
  v_mfma_f32_16x16x32_bf16 v[160:163], a[24:27], v[128:131], v[160:163]
  ds_read_b128 v[156:159], v35 offset:23552
  s_waitcnt lgkmcnt(6)
  v_mfma_f32_16x16x32_bf16 v[164:167], a[24:27], v[132:135], v[164:167]
  s_waitcnt vmcnt(13)
  s_waitcnt lgkmcnt(5)
  v_mfma_f32_16x16x32_bf16 v[168:171], a[24:27], v[136:139], v[168:171]
  s_waitcnt lgkmcnt(4)
  v_mfma_f32_16x16x32_bf16 v[172:175], a[24:27], v[140:143], v[172:175]
  s_waitcnt lgkmcnt(3)
  v_mfma_f32_16x16x32_bf16 v[160:163], a[28:31], v[144:147], v[160:163]
  s_lshl_b32 s22, s15, 10
  s_lshl_b32 s23, s16, 4
  s_add_u32 s22, s22, s23
  s_lshl_b32 s23, s14, 2
  s_add_u32 s22, s22, s23
  s_add_u32 s22, s22, 2228992
  v_mov_b32 v27, s22
  v_mov_b32 v28, 1
  s_mov_b64 s[36:37], exec
  s_mov_b64 exec, 1
  global_store_dword v27, v28, s[6:7] sc1
  s_mov_b64 exec, s[36:37]
  s_waitcnt lgkmcnt(2)
  v_mfma_f32_16x16x32_bf16 v[164:167], a[28:31], v[148:151], v[164:167]
  s_waitcnt lgkmcnt(1)
  v_mfma_f32_16x16x32_bf16 v[168:171], a[28:31], v[152:155], v[168:171]
  s_waitcnt lgkmcnt(0)
  v_mfma_f32_16x16x32_bf16 v[172:175], a[28:31], v[156:159], v[172:175]
  s_waitcnt vmcnt(16)
  s_barrier
  ds_read_b128 v[128:131], v32 offset:8192
  ds_read_b128 v[132:135], v33 offset:8192
  ds_read_b128 v[136:139], v34 offset:8192
  ds_read_b128 v[140:143], v35 offset:8192
  ds_read_b128 v[144:147], v32 offset:9216
  ds_read_b128 v[148:151], v33 offset:9216
  ds_read_b128 v[152:155], v34 offset:9216
  s_waitcnt lgkmcnt(6)
  s_add_u32 m0, s21, 36864
  v_mfma_f32_16x16x32_bf16 v[160:163], a[32:35], v[128:131], v[160:163]
  global_load_lds_dwordx4 v7, s[24:25] offset:0 sc1
  global_load_lds_dwordx4 v7, s[24:25] offset:1024 sc1
  ds_read_b128 v[156:159], v35 offset:9216
  s_waitcnt lgkmcnt(6)
  v_mfma_f32_16x16x32_bf16 v[164:167], a[32:35], v[132:135], v[164:167]
  ds_read_b128 v[128:131], v32 offset:10240
  s_waitcnt lgkmcnt(6)
  s_add_u32 m0, s21, 36864
  v_mfma_f32_16x16x32_bf16 v[168:171], a[32:35], v[136:139], v[168:171]
  global_load_lds_dwordx4 v7, s[24:25] offset:2048 sc1
  global_load_lds_dwordx4 v7, s[24:25] offset:3072 sc1
  v_add_u32 v7, 0x2000, v7
  ds_read_b128 v[132:135], v33 offset:10240
  s_waitcnt lgkmcnt(6)
  v_mfma_f32_16x16x32_bf16 v[172:175], a[32:35], v[140:143], v[172:175]
  ds_read_b128 v[136:139], v34 offset:10240
  s_waitcnt lgkmcnt(6)
  v_mfma_f32_16x16x32_bf16 v[160:163], a[36:39], v[144:147], v[160:163]
  ds_read_b128 v[140:143], v35 offset:10240
  s_waitcnt lgkmcnt(6)
  v_mfma_f32_16x16x32_bf16 v[164:167], a[36:39], v[148:151], v[164:167]
  s_lshl_b32 s22, s15, 10
  s_add_u32 s22, s22, 2228736
  v_lshl_add_u32 v30, v2, 2, s22
  global_load_dword v29, v30, s[6:7] sc1
  ds_read_b128 v[144:147], v32 offset:11264
  s_waitcnt lgkmcnt(6)
  v_mfma_f32_16x16x32_bf16 v[168:171], a[36:39], v[152:155], v[168:171]
  ds_read_b128 v[148:151], v33 offset:11264
  s_waitcnt lgkmcnt(6)
  v_mfma_f32_16x16x32_bf16 v[172:175], a[36:39], v[156:159], v[172:175]
  ds_read_b128 v[152:155], v34 offset:11264
  s_waitcnt lgkmcnt(6)
  v_mfma_f32_16x16x32_bf16 v[160:163], a[40:43], v[128:131], v[160:163]
  s_lshl_b32 s22, s46, 14
  v_add_u32 v17, s22, v14
  global_load_dwordx4 v[176:179], v17, s[6:7] sc1
  v_add_u32 v17, s22, v15
  global_load_dwordx4 v[180:183], v17, s[6:7] sc1
  ds_read_b128 v[156:159], v35 offset:11264
  s_waitcnt lgkmcnt(6)
  v_mfma_f32_16x16x32_bf16 v[164:167], a[40:43], v[132:135], v[164:167]
  ds_read_b128 v[128:131], v32 offset:12288
  s_waitcnt lgkmcnt(6)
  v_mfma_f32_16x16x32_bf16 v[168:171], a[40:43], v[136:139], v[168:171]
  ds_read_b128 v[132:135], v33 offset:12288
  s_waitcnt lgkmcnt(6)
  v_mfma_f32_16x16x32_bf16 v[172:175], a[40:43], v[140:143], v[172:175]
  s_lshl_b32 s22, s46, 6
  v_add_u32 v17, s22, v6
  global_load_dword v216, v17, s[6:7] sc1
  ds_read_b128 v[136:139], v34 offset:12288
  s_waitcnt lgkmcnt(6)
  v_mfma_f32_16x16x32_bf16 v[160:163], a[44:47], v[144:147], v[160:163]
  ds_read_b128 v[140:143], v35 offset:12288
  s_waitcnt lgkmcnt(6)
  v_mfma_f32_16x16x32_bf16 v[164:167], a[44:47], v[148:151], v[164:167]
  ds_read_b128 v[144:147], v32 offset:13312
  s_waitcnt lgkmcnt(6)
  v_mfma_f32_16x16x32_bf16 v[168:171], a[44:47], v[152:155], v[168:171]
  s_lshl_b32 s22, s47, 14
  v_add_u32 v17, s22, v14
  global_load_dwordx4 v[184:187], v17, s[6:7] sc1
  v_add_u32 v17, s22, v15
  global_load_dwordx4 v[188:191], v17, s[6:7] sc1
  ds_read_b128 v[148:151], v33 offset:13312
  s_waitcnt lgkmcnt(6)
  v_mfma_f32_16x16x32_bf16 v[172:175], a[44:47], v[156:159], v[172:175]
  ds_read_b128 v[152:155], v34 offset:13312
  s_waitcnt lgkmcnt(6)
  v_mfma_f32_16x16x32_bf16 v[160:163], a[48:51], v[128:131], v[160:163]
  ds_read_b128 v[156:159], v35 offset:13312
  s_waitcnt lgkmcnt(6)
  v_mfma_f32_16x16x32_bf16 v[164:167], a[48:51], v[132:135], v[164:167]
  s_lshl_b32 s22, s47, 6
  v_add_u32 v17, s22, v6
  global_load_dword v217, v17, s[6:7] sc1
  ds_read_b128 v[128:131], v32 offset:14336
  s_waitcnt lgkmcnt(6)
  v_mfma_f32_16x16x32_bf16 v[168:171], a[48:51], v[136:139], v[168:171]
  ds_read_b128 v[132:135], v33 offset:14336
  s_waitcnt lgkmcnt(6)
  v_mfma_f32_16x16x32_bf16 v[172:175], a[48:51], v[140:143], v[172:175]
  ds_read_b128 v[136:139], v34 offset:14336
  s_waitcnt lgkmcnt(6)
  v_mfma_f32_16x16x32_bf16 v[160:163], a[52:55], v[144:147], v[160:163]
  s_lshl_b32 s22, s48, 14
  v_add_u32 v17, s22, v14
  global_load_dwordx4 v[192:195], v17, s[6:7] sc1
  v_add_u32 v17, s22, v15
  global_load_dwordx4 v[196:199], v17, s[6:7] sc1
  ds_read_b128 v[140:143], v35 offset:14336
  s_waitcnt lgkmcnt(6)
  v_mfma_f32_16x16x32_bf16 v[164:167], a[52:55], v[148:151], v[164:167]
  ds_read_b128 v[144:147], v32 offset:15360
  s_waitcnt lgkmcnt(6)
  v_mfma_f32_16x16x32_bf16 v[168:171], a[52:55], v[152:155], v[168:171]
  ds_read_b128 v[148:151], v33 offset:15360
  s_waitcnt lgkmcnt(6)
  v_mfma_f32_16x16x32_bf16 v[172:175], a[52:55], v[156:159], v[172:175]
  s_lshl_b32 s22, s48, 6
  v_add_u32 v17, s22, v6
  global_load_dword v218, v17, s[6:7] sc1
  ds_read_b128 v[152:155], v34 offset:15360
  s_waitcnt lgkmcnt(6)
  v_mfma_f32_16x16x32_bf16 v[160:163], a[56:59], v[128:131], v[160:163]
  ds_read_b128 v[156:159], v35 offset:15360
  s_waitcnt lgkmcnt(6)
  v_mfma_f32_16x16x32_bf16 v[164:167], a[56:59], v[132:135], v[164:167]
  s_waitcnt lgkmcnt(5)
  v_mfma_f32_16x16x32_bf16 v[168:171], a[56:59], v[136:139], v[168:171]
  s_lshl_b32 s22, s49, 14
  v_add_u32 v17, s22, v14
  global_load_dwordx4 v[200:203], v17, s[6:7] sc1
  v_add_u32 v17, s22, v15
  global_load_dwordx4 v[204:207], v17, s[6:7] sc1
  s_waitcnt lgkmcnt(4)
  v_mfma_f32_16x16x32_bf16 v[172:175], a[56:59], v[140:143], v[172:175]
  s_waitcnt lgkmcnt(3)
  v_mfma_f32_16x16x32_bf16 v[160:163], a[60:63], v[144:147], v[160:163]
  s_waitcnt lgkmcnt(2)
  v_mfma_f32_16x16x32_bf16 v[164:167], a[60:63], v[148:151], v[164:167]
  s_lshl_b32 s22, s49, 6
  v_add_u32 v17, s22, v6
  global_load_dword v219, v17, s[6:7] sc1
  s_waitcnt lgkmcnt(1)
  v_mfma_f32_16x16x32_bf16 v[168:171], a[60:63], v[152:155], v[168:171]
  s_waitcnt lgkmcnt(0)
  v_mfma_f32_16x16x32_bf16 v[172:175], a[60:63], v[156:159], v[172:175]
  s_waitcnt vmcnt(22)
  s_barrier
  ds_read_b128 v[128:131], v32 offset:24576
  ds_read_b128 v[132:135], v33 offset:24576
  ds_read_b128 v[136:139], v34 offset:24576
  ds_read_b128 v[140:143], v35 offset:24576
  ds_read_b128 v[144:147], v32 offset:25600
  ds_read_b128 v[148:151], v33 offset:25600
  ds_read_b128 v[152:155], v34 offset:25600
  s_waitcnt lgkmcnt(6)
  v_mfma_f32_16x16x32_bf16 v[160:163], a[64:67], v[128:131], v[160:163]
  s_waitcnt vmcnt(12)
  ds_read_b128 v[156:159], v35 offset:25600
  s_waitcnt lgkmcnt(6)
  v_mfma_f32_16x16x32_bf16 v[164:167], a[64:67], v[132:135], v[164:167]
  ds_read_b128 v[128:131], v32 offset:26624
  s_waitcnt lgkmcnt(6)
  v_mfma_f32_16x16x32_bf16 v[168:171], a[64:67], v[136:139], v[168:171]
  v_cmp_eq_u32 vcc, 1, v29
  s_nop 0
  s_cmp_eq_u64 vcc, exec
  s_cbranch_scc1 KD_readyC
  s_mov_b32 s23, 0
KD_pollC:
  global_load_dword v29, v30, s[6:7] sc1
  s_waitcnt vmcnt(0)
  v_cmp_eq_u32 vcc, 1, v29
  s_add_u32 s23, s23, 1
  s_cmp_eq_u64 vcc, exec
  s_cbranch_scc1 KD_readyC
  s_cmp_lt_u32 s23, 0x20000
  s_cbranch_scc1 KD_pollC
KD_readyC:
  ds_read_b128 v[132:135], v33 offset:26624
  s_waitcnt lgkmcnt(6)
  v_mfma_f32_16x16x32_bf16 v[172:175], a[64:67], v[140:143], v[172:175]
  ds_read_b128 v[136:139], v34 offset:26624
  s_waitcnt lgkmcnt(6)
  v_mfma_f32_16x16x32_bf16 v[160:163], a[68:71], v[144:147], v[160:163]
  ds_read_b128 v[140:143], v35 offset:26624
  s_waitcnt lgkmcnt(6)
  s_add_u32 m0, s21, 0
  v_mfma_f32_16x16x32_bf16 v[164:167], a[68:71], v[148:151], v[164:167]
  global_load_lds_dwordx4 v7, s[6:7] offset:0 sc1
  global_load_lds_dwordx4 v7, s[6:7] offset:1024 sc1
  ds_read_b128 v[144:147], v32 offset:27648
  s_waitcnt lgkmcnt(6)
  v_mfma_f32_16x16x32_bf16 v[168:171], a[68:71], v[152:155], v[168:171]
  ds_read_b128 v[148:151], v33 offset:27648
  s_waitcnt lgkmcnt(6)
  v_mfma_f32_16x16x32_bf16 v[172:175], a[68:71], v[156:159], v[172:175]
  ds_read_b128 v[152:155], v34 offset:27648
  s_waitcnt lgkmcnt(6)
  s_add_u32 m0, s21, 0
  v_mfma_f32_16x16x32_bf16 v[160:163], a[72:75], v[128:131], v[160:163]
  global_load_lds_dwordx4 v7, s[6:7] offset:2048 sc1
  global_load_lds_dwordx4 v7, s[6:7] offset:3072 sc1
  ds_read_b128 v[156:159], v35 offset:27648
  s_waitcnt lgkmcnt(6)
  v_mfma_f32_16x16x32_bf16 v[164:167], a[72:75], v[132:135], v[164:167]
  ds_read_b128 v[128:131], v32 offset:28672
  s_waitcnt lgkmcnt(6)
  v_mfma_f32_16x16x32_bf16 v[168:171], a[72:75], v[136:139], v[168:171]
  ds_read_b128 v[132:135], v33 offset:28672
  s_waitcnt lgkmcnt(6)
  s_add_u32 m0, s21, 4096
  v_mfma_f32_16x16x32_bf16 v[172:175], a[72:75], v[140:143], v[172:175]
  global_load_lds_dwordx4 v7, s[24:25] offset:0 sc1
  global_load_lds_dwordx4 v7, s[24:25] offset:1024 sc1
  ds_read_b128 v[136:139], v34 offset:28672
  s_waitcnt lgkmcnt(6)
  v_mfma_f32_16x16x32_bf16 v[160:163], a[76:79], v[144:147], v[160:163]
  ds_read_b128 v[140:143], v35 offset:28672
  s_waitcnt lgkmcnt(6)
  v_mfma_f32_16x16x32_bf16 v[164:167], a[76:79], v[148:151], v[164:167]
  ds_read_b128 v[144:147], v32 offset:29696
  s_waitcnt lgkmcnt(6)
  s_add_u32 m0, s21, 4096
  v_mfma_f32_16x16x32_bf16 v[168:171], a[76:79], v[152:155], v[168:171]
  global_load_lds_dwordx4 v7, s[24:25] offset:2048 sc1
  global_load_lds_dwordx4 v7, s[24:25] offset:3072 sc1
  v_add_u32 v7, 0x2000, v7
  ds_read_b128 v[148:151], v33 offset:29696
  s_waitcnt lgkmcnt(6)
  v_mfma_f32_16x16x32_bf16 v[172:175], a[76:79], v[156:159], v[172:175]
  ds_read_b128 v[152:155], v34 offset:29696
  s_waitcnt lgkmcnt(6)
  v_mfma_f32_16x16x32_bf16 v[160:163], a[80:83], v[128:131], v[160:163]
  ds_read_b128 v[156:159], v35 offset:29696
  s_waitcnt lgkmcnt(6)
  v_mfma_f32_16x16x32_bf16 v[164:167], a[80:83], v[132:135], v[164:167]
  s_lshl_b32 s22, s15, 10
  s_add_u32 s22, s22, 2228992
  v_lshl_add_u32 v30, v2, 2, s22
  global_load_dword v29, v30, s[6:7] sc1
  ds_read_b128 v[128:131], v32 offset:30720
  s_waitcnt lgkmcnt(6)
  v_mfma_f32_16x16x32_bf16 v[168:171], a[80:83], v[136:139], v[168:171]
  ds_read_b128 v[132:135], v33 offset:30720
  s_waitcnt lgkmcnt(6)
  v_mfma_f32_16x16x32_bf16 v[172:175], a[80:83], v[140:143], v[172:175]
  ds_read_b128 v[136:139], v34 offset:30720
  s_waitcnt lgkmcnt(6)
  s_add_u32 m0, s21, 16384
  v_mfma_f32_16x16x32_bf16 v[160:163], a[84:87], v[144:147], v[160:163]
  global_load_lds_dwordx4 v7, s[6:7] offset:0 sc1
  global_load_lds_dwordx4 v7, s[6:7] offset:1024 sc1
  ds_read_b128 v[140:143], v35 offset:30720
  s_waitcnt lgkmcnt(6)
  v_mfma_f32_16x16x32_bf16 v[164:167], a[84:87], v[148:151], v[164:167]
  ds_read_b128 v[144:147], v32 offset:31744
  s_waitcnt lgkmcnt(6)
  v_mfma_f32_16x16x32_bf16 v[168:171], a[84:87], v[152:155], v[168:171]
  ds_read_b128 v[148:151], v33 offset:31744
  s_waitcnt lgkmcnt(6)
  s_add_u32 m0, s21, 16384
  v_mfma_f32_16x16x32_bf16 v[172:175], a[84:87], v[156:159], v[172:175]
  global_load_lds_dwordx4 v7, s[6:7] offset:2048 sc1
  global_load_lds_dwordx4 v7, s[6:7] offset:3072 sc1
  ds_read_b128 v[152:155], v34 offset:31744
  s_waitcnt lgkmcnt(6)
  v_mfma_f32_16x16x32_bf16 v[160:163], a[88:91], v[128:131], v[160:163]
  ds_read_b128 v[156:159], v35 offset:31744
  s_waitcnt lgkmcnt(6)
  v_mfma_f32_16x16x32_bf16 v[164:167], a[88:91], v[132:135], v[164:167]
  s_waitcnt lgkmcnt(5)
  s_add_u32 m0, s21, 20480
  v_mfma_f32_16x16x32_bf16 v[168:171], a[88:91], v[136:139], v[168:171]
  global_load_lds_dwordx4 v7, s[24:25] offset:0 sc1
  global_load_lds_dwordx4 v7, s[24:25] offset:1024 sc1
  s_waitcnt lgkmcnt(4)
  v_mfma_f32_16x16x32_bf16 v[172:175], a[88:91], v[140:143], v[172:175]
  s_waitcnt lgkmcnt(3)
  v_mfma_f32_16x16x32_bf16 v[160:163], a[92:95], v[144:147], v[160:163]
  s_waitcnt lgkmcnt(2)
  s_add_u32 m0, s21, 20480
  v_mfma_f32_16x16x32_bf16 v[164:167], a[92:95], v[148:151], v[164:167]
  global_load_lds_dwordx4 v7, s[24:25] offset:2048 sc1
  global_load_lds_dwordx4 v7, s[24:25] offset:3072 sc1
  v_add_u32 v7, 0x2000, v7
  s_waitcnt lgkmcnt(1)
  v_mfma_f32_16x16x32_bf16 v[168:171], a[92:95], v[152:155], v[168:171]
  s_waitcnt lgkmcnt(0)
  v_mfma_f32_16x16x32_bf16 v[172:175], a[92:95], v[156:159], v[172:175]
  s_waitcnt vmcnt(30)
  s_barrier
  ds_read_b128 v[128:131], v32 offset:32768
  ds_read_b128 v[132:135], v33 offset:32768
  ds_read_b128 v[136:139], v34 offset:32768
  ds_read_b128 v[140:143], v35 offset:32768
  ds_read_b128 v[144:147], v32 offset:33792
  ds_read_b128 v[148:151], v33 offset:33792
  ds_read_b128 v[152:155], v34 offset:33792
  s_waitcnt lgkmcnt(6)
  v_mfma_f32_16x16x32_bf16 v[160:163], a[96:99], v[128:131], v[160:163]
  s_nop 0
  ds_read_b128 v[156:159], v35 offset:33792
  s_waitcnt lgkmcnt(6)
  v_mfma_f32_16x16x32_bf16 v[164:167], a[96:99], v[132:135], v[164:167]
  s_nop 0
  ds_read_b128 v[128:131], v32 offset:34816
  s_waitcnt lgkmcnt(6)
  v_mfma_f32_16x16x32_bf16 v[168:171], a[96:99], v[136:139], v[168:171]
  s_nop 0
  ds_read_b128 v[132:135], v33 offset:34816
  s_waitcnt lgkmcnt(6)
  v_mfma_f32_16x16x32_bf16 v[172:175], a[96:99], v[140:143], v[172:175]
  ds_read_b128 v[136:139], v34 offset:34816
  s_waitcnt lgkmcnt(6)
  v_mfma_f32_16x16x32_bf16 v[160:163], a[100:103], v[144:147], v[160:163]
  s_nop 0
  ds_read_b128 v[140:143], v35 offset:34816
  s_waitcnt lgkmcnt(6)
  v_mfma_f32_16x16x32_bf16 v[164:167], a[100:103], v[148:151], v[164:167]
  s_nop 0
  ds_read_b128 v[144:147], v32 offset:35840
  s_waitcnt lgkmcnt(6)
  v_mfma_f32_16x16x32_bf16 v[168:171], a[100:103], v[152:155], v[168:171]
  ds_read_b128 v[148:151], v33 offset:35840
  s_waitcnt lgkmcnt(6)
  v_mfma_f32_16x16x32_bf16 v[172:175], a[100:103], v[156:159], v[172:175]
  s_nop 0
  ds_read_b128 v[152:155], v34 offset:35840
  s_waitcnt lgkmcnt(6)
  v_mfma_f32_16x16x32_bf16 v[160:163], a[104:107], v[128:131], v[160:163]
  s_nop 0
  ds_read_b128 v[156:159], v35 offset:35840
  s_waitcnt lgkmcnt(6)
  v_mfma_f32_16x16x32_bf16 v[164:167], a[104:107], v[132:135], v[164:167]
  ds_read_b128 v[128:131], v32 offset:36864
  s_waitcnt lgkmcnt(6)
  v_mfma_f32_16x16x32_bf16 v[168:171], a[104:107], v[136:139], v[168:171]
  s_nop 0
  ds_read_b128 v[132:135], v33 offset:36864
  s_waitcnt lgkmcnt(6)
  v_mfma_f32_16x16x32_bf16 v[172:175], a[104:107], v[140:143], v[172:175]
  s_nop 0
  ds_read_b128 v[136:139], v34 offset:36864
  s_waitcnt lgkmcnt(6)
  v_mfma_f32_16x16x32_bf16 v[160:163], a[108:111], v[144:147], v[160:163]
  ds_read_b128 v[140:143], v35 offset:36864
  s_waitcnt lgkmcnt(6)
  v_mfma_f32_16x16x32_bf16 v[164:167], a[108:111], v[148:151], v[164:167]
  s_nop 0
  ds_read_b128 v[144:147], v32 offset:37888
  s_waitcnt lgkmcnt(6)
  v_mfma_f32_16x16x32_bf16 v[168:171], a[108:111], v[152:155], v[168:171]
  s_nop 0
  ds_read_b128 v[148:151], v33 offset:37888
  s_waitcnt lgkmcnt(6)
  v_mfma_f32_16x16x32_bf16 v[172:175], a[108:111], v[156:159], v[172:175]
  ds_read_b128 v[152:155], v34 offset:37888
  s_waitcnt lgkmcnt(6)
  v_mfma_f32_16x16x32_bf16 v[160:163], a[112:115], v[128:131], v[160:163]
  s_nop 0
  ds_read_b128 v[156:159], v35 offset:37888
  s_waitcnt lgkmcnt(6)
  v_mfma_f32_16x16x32_bf16 v[164:167], a[112:115], v[132:135], v[164:167]
  s_nop 0
  ds_read_b128 v[128:131], v32 offset:38912
  s_waitcnt lgkmcnt(6)
  v_mfma_f32_16x16x32_bf16 v[168:171], a[112:115], v[136:139], v[168:171]
  s_nop 0
  ds_read_b128 v[132:135], v33 offset:38912
  s_waitcnt lgkmcnt(6)
  v_mfma_f32_16x16x32_bf16 v[172:175], a[112:115], v[140:143], v[172:175]
  ds_read_b128 v[136:139], v34 offset:38912
  s_waitcnt lgkmcnt(6)
  v_mfma_f32_16x16x32_bf16 v[160:163], a[116:119], v[144:147], v[160:163]
  s_nop 0
  ds_read_b128 v[140:143], v35 offset:38912
  s_waitcnt lgkmcnt(6)
  v_mfma_f32_16x16x32_bf16 v[164:167], a[116:119], v[148:151], v[164:167]
  s_nop 0
  ds_read_b128 v[144:147], v32 offset:39936
  s_waitcnt lgkmcnt(6)
  v_mfma_f32_16x16x32_bf16 v[168:171], a[116:119], v[152:155], v[168:171]
  ds_read_b128 v[148:151], v33 offset:39936
  s_waitcnt lgkmcnt(6)
  v_mfma_f32_16x16x32_bf16 v[172:175], a[116:119], v[156:159], v[172:175]
  s_waitcnt vmcnt(8)
  ds_read_b128 v[152:155], v34 offset:39936
  s_waitcnt lgkmcnt(6)
  v_mfma_f32_16x16x32_bf16 v[160:163], a[120:123], v[128:131], v[160:163]
  v_cmp_eq_u32 vcc, 1, v29
  s_nop 0
  s_cmp_eq_u64 vcc, exec
  s_cbranch_scc1 KD_readyD
  s_mov_b32 s23, 0
KD_pollD:
  global_load_dword v29, v30, s[6:7] sc1
  s_waitcnt vmcnt(0)
  v_cmp_eq_u32 vcc, 1, v29
  s_add_u32 s23, s23, 1
  s_cmp_eq_u64 vcc, exec
  s_cbranch_scc1 KD_readyD
  s_cmp_lt_u32 s23, 0x20000
  s_cbranch_scc1 KD_pollD
KD_readyD:
  ds_read_b128 v[156:159], v35 offset:39936
  s_waitcnt lgkmcnt(6)
  v_mfma_f32_16x16x32_bf16 v[164:167], a[120:123], v[132:135], v[164:167]
  s_waitcnt lgkmcnt(5)
  s_add_u32 m0, s21, 8192
  v_mfma_f32_16x16x32_bf16 v[168:171], a[120:123], v[136:139], v[168:171]
  global_load_lds_dwordx4 v7, s[6:7] offset:0 sc1
  global_load_lds_dwordx4 v7, s[6:7] offset:1024 sc1
  s_waitcnt lgkmcnt(4)
  s_add_u32 m0, s21, 8192
  v_mfma_f32_16x16x32_bf16 v[172:175], a[120:123], v[140:143], v[172:175]
  global_load_lds_dwordx4 v7, s[6:7] offset:2048 sc1
  global_load_lds_dwordx4 v7, s[6:7] offset:3072 sc1
  s_waitcnt lgkmcnt(3)
  v_mfma_f32_16x16x32_bf16 v[160:163], a[124:127], v[144:147], v[160:163]
  s_waitcnt lgkmcnt(2)
  s_add_u32 m0, s21, 12288
  v_mfma_f32_16x16x32_bf16 v[164:167], a[124:127], v[148:151], v[164:167]
  global_load_lds_dwordx4 v7, s[24:25] offset:0 sc1
  global_load_lds_dwordx4 v7, s[24:25] offset:1024 sc1
  s_waitcnt lgkmcnt(1)
  s_add_u32 m0, s21, 12288
  v_mfma_f32_16x16x32_bf16 v[168:171], a[124:127], v[152:155], v[168:171]
  global_load_lds_dwordx4 v7, s[24:25] offset:2048 sc1
  global_load_lds_dwordx4 v7, s[24:25] offset:3072 sc1
  v_add_u32 v7, 0x2000, v7
  s_waitcnt lgkmcnt(0)
  v_mfma_f32_16x16x32_bf16 v[172:175], a[124:127], v[156:159], v[172:175]
  s_waitcnt vmcnt(17)
  s_barrier
  ds_read_b128 v[128:131], v32 offset:0
  ds_read_b128 v[132:135], v33 offset:0
  ds_read_b128 v[136:139], v34 offset:0
  ds_read_b128 v[140:143], v35 offset:0
  ds_read_b128 v[144:147], v32 offset:1024
  ds_read_b128 v[148:151], v33 offset:1024
  ds_read_b128 v[152:155], v34 offset:1024
  s_waitcnt lgkmcnt(6)
  v_mfma_f32_16x16x32_bf16 v[160:163], a[128:131], v[128:131], v[160:163]
  ds_read_b128 v[156:159], v35 offset:1024
  s_waitcnt lgkmcnt(6)
  v_mfma_f32_16x16x32_bf16 v[164:167], a[128:131], v[132:135], v[164:167]
  ds_read_b128 v[128:131], v32 offset:2048
  s_waitcnt lgkmcnt(6)
  v_mfma_f32_16x16x32_bf16 v[168:171], a[128:131], v[136:139], v[168:171]
  ds_read_b128 v[132:135], v33 offset:2048
  s_waitcnt lgkmcnt(6)
  v_mfma_f32_16x16x32_bf16 v[172:175], a[128:131], v[140:143], v[172:175]
  ds_read_b128 v[136:139], v34 offset:2048
  s_waitcnt lgkmcnt(6)
  v_mfma_f32_16x16x32_bf16 v[160:163], a[132:135], v[144:147], v[160:163]
  ds_read_b128 v[140:143], v35 offset:2048
  s_waitcnt lgkmcnt(6)
  v_mfma_f32_16x16x32_bf16 v[164:167], a[132:135], v[148:151], v[164:167]
  ds_read_b128 v[144:147], v32 offset:3072
  s_waitcnt lgkmcnt(6)
  v_mfma_f32_16x16x32_bf16 v[168:171], a[132:135], v[152:155], v[168:171]
  ds_read_b128 v[148:151], v33 offset:3072
  s_waitcnt lgkmcnt(6)
  v_mfma_f32_16x16x32_bf16 v[172:175], a[132:135], v[156:159], v[172:175]
  ds_read_b128 v[152:155], v34 offset:3072
  s_waitcnt lgkmcnt(6)
  v_mfma_f32_16x16x32_bf16 v[160:163], a[136:139], v[128:131], v[160:163]
  ds_read_b128 v[156:159], v35 offset:3072
  s_waitcnt lgkmcnt(6)
  v_mfma_f32_16x16x32_bf16 v[164:167], a[136:139], v[132:135], v[164:167]
  ds_read_b128 v[128:131], v32 offset:4096
  s_waitcnt lgkmcnt(6)
  v_mfma_f32_16x16x32_bf16 v[168:171], a[136:139], v[136:139], v[168:171]
  ds_read_b128 v[132:135], v33 offset:4096
  s_waitcnt lgkmcnt(6)
  v_mfma_f32_16x16x32_bf16 v[172:175], a[136:139], v[140:143], v[172:175]
  ds_read_b128 v[136:139], v34 offset:4096
  s_waitcnt lgkmcnt(6)
  v_mfma_f32_16x16x32_bf16 v[160:163], a[140:143], v[144:147], v[160:163]
  ds_read_b128 v[140:143], v35 offset:4096
  s_waitcnt lgkmcnt(6)
  v_mfma_f32_16x16x32_bf16 v[164:167], a[140:143], v[148:151], v[164:167]
  ds_read_b128 v[144:147], v32 offset:5120
  s_waitcnt lgkmcnt(6)
  v_mfma_f32_16x16x32_bf16 v[168:171], a[140:143], v[152:155], v[168:171]
  ds_read_b128 v[148:151], v33 offset:5120
  s_waitcnt lgkmcnt(6)
  v_mfma_f32_16x16x32_bf16 v[172:175], a[140:143], v[156:159], v[172:175]
  ds_read_b128 v[152:155], v34 offset:5120
  s_waitcnt lgkmcnt(6)
  v_mfma_f32_16x16x32_bf16 v[160:163], a[144:147], v[128:131], v[160:163]
  ds_read_b128 v[156:159], v35 offset:5120
  s_waitcnt lgkmcnt(6)
  v_mfma_f32_16x16x32_bf16 v[164:167], a[144:147], v[132:135], v[164:167]
  ds_read_b128 v[128:131], v32 offset:6144
  s_waitcnt lgkmcnt(6)
  v_mfma_f32_16x16x32_bf16 v[168:171], a[144:147], v[136:139], v[168:171]
  ds_read_b128 v[132:135], v33 offset:6144
  s_waitcnt lgkmcnt(6)
  v_mfma_f32_16x16x32_bf16 v[172:175], a[144:147], v[140:143], v[172:175]
  ds_read_b128 v[136:139], v34 offset:6144
  s_waitcnt lgkmcnt(6)
  v_mfma_f32_16x16x32_bf16 v[160:163], a[148:151], v[144:147], v[160:163]
  ds_read_b128 v[140:143], v35 offset:6144
  s_waitcnt lgkmcnt(6)
  v_mfma_f32_16x16x32_bf16 v[164:167], a[148:151], v[148:151], v[164:167]
  ds_read_b128 v[144:147], v32 offset:7168
  s_waitcnt lgkmcnt(6)
  v_mfma_f32_16x16x32_bf16 v[168:171], a[148:151], v[152:155], v[168:171]
  ds_read_b128 v[148:151], v33 offset:7168
  s_waitcnt lgkmcnt(6)
  v_mfma_f32_16x16x32_bf16 v[172:175], a[148:151], v[156:159], v[172:175]
  ds_read_b128 v[152:155], v34 offset:7168
  s_waitcnt lgkmcnt(6)
  v_mfma_f32_16x16x32_bf16 v[160:163], a[152:155], v[128:131], v[160:163]
  ds_read_b128 v[156:159], v35 offset:7168
  s_waitcnt lgkmcnt(6)
  v_mfma_f32_16x16x32_bf16 v[164:167], a[152:155], v[132:135], v[164:167]
  s_waitcnt lgkmcnt(5)
  v_mfma_f32_16x16x32_bf16 v[168:171], a[152:155], v[136:139], v[168:171]
  s_waitcnt lgkmcnt(4)
  v_mfma_f32_16x16x32_bf16 v[172:175], a[152:155], v[140:143], v[172:175]
  s_waitcnt lgkmcnt(3)
  v_mfma_f32_16x16x32_bf16 v[160:163], a[156:159], v[144:147], v[160:163]
  s_waitcnt lgkmcnt(2)
  v_mfma_f32_16x16x32_bf16 v[164:167], a[156:159], v[148:151], v[164:167]
  s_waitcnt lgkmcnt(1)
  v_mfma_f32_16x16x32_bf16 v[168:171], a[156:159], v[152:155], v[168:171]
  s_waitcnt lgkmcnt(0)
  v_mfma_f32_16x16x32_bf16 v[172:175], a[156:159], v[156:159], v[172:175]
  v_mfma_f32_16x16x32_bf16 v[160:163], v[104:107], v[176:179], v[160:163]
  v_mfma_f32_16x16x32_bf16 v[164:167], v[104:107], v[184:187], v[164:167]
  v_mfma_f32_16x16x32_bf16 v[168:171], v[104:107], v[192:195], v[168:171]
  v_mfma_f32_16x16x32_bf16 v[172:175], v[104:107], v[200:203], v[172:175]
  v_mfma_f32_16x16x32_bf16 v[160:163], v[108:111], v[180:183], v[160:163]
  v_mfma_f32_16x16x32_bf16 v[164:167], v[108:111], v[188:191], v[164:167]
  v_mfma_f32_16x16x32_bf16 v[168:171], v[108:111], v[196:199], v[168:171]
  v_mfma_f32_16x16x32_bf16 v[172:175], v[108:111], v[204:207], v[172:175]
  s_waitcnt vmcnt(8)
  s_barrier
  ds_read_b128 v[128:131], v32 offset:16384
  ds_read_b128 v[132:135], v33 offset:16384
  ds_read_b128 v[136:139], v34 offset:16384
  ds_read_b128 v[140:143], v35 offset:16384
  ds_read_b128 v[144:147], v32 offset:17408
  ds_read_b128 v[148:151], v33 offset:17408
  ds_read_b128 v[152:155], v34 offset:17408
  s_waitcnt lgkmcnt(6)
  v_mfma_f32_16x16x32_bf16 v[160:163], a[192:195], v[128:131], v[160:163]
  ds_read_b128 v[156:159], v35 offset:17408
  s_waitcnt lgkmcnt(6)
  v_mfma_f32_16x16x32_bf16 v[164:167], a[192:195], v[132:135], v[164:167]
  ds_read_b128 v[128:131], v32 offset:18432
  s_waitcnt lgkmcnt(6)
  v_mfma_f32_16x16x32_bf16 v[168:171], a[192:195], v[136:139], v[168:171]
  ds_read_b128 v[132:135], v33 offset:18432
  s_waitcnt lgkmcnt(6)
  v_mfma_f32_16x16x32_bf16 v[172:175], a[192:195], v[140:143], v[172:175]
  ds_read_b128 v[136:139], v34 offset:18432
  s_waitcnt lgkmcnt(6)
  v_mfma_f32_16x16x32_bf16 v[160:163], a[196:199], v[144:147], v[160:163]
  ds_read_b128 v[140:143], v35 offset:18432
  s_waitcnt lgkmcnt(6)
  v_mfma_f32_16x16x32_bf16 v[164:167], a[196:199], v[148:151], v[164:167]
  ds_read_b128 v[144:147], v32 offset:19456
  s_waitcnt lgkmcnt(6)
  v_mfma_f32_16x16x32_bf16 v[168:171], a[196:199], v[152:155], v[168:171]
  ds_read_b128 v[148:151], v33 offset:19456
  s_waitcnt lgkmcnt(6)
  v_mfma_f32_16x16x32_bf16 v[172:175], a[196:199], v[156:159], v[172:175]
  ds_read_b128 v[152:155], v34 offset:19456
  s_waitcnt lgkmcnt(6)
  v_mfma_f32_16x16x32_bf16 v[160:163], a[200:203], v[128:131], v[160:163]
  ds_read_b128 v[156:159], v35 offset:19456
  s_waitcnt lgkmcnt(6)
  v_mfma_f32_16x16x32_bf16 v[164:167], a[200:203], v[132:135], v[164:167]
  ds_read_b128 v[128:131], v32 offset:20480
  s_waitcnt lgkmcnt(6)
  v_mfma_f32_16x16x32_bf16 v[168:171], a[200:203], v[136:139], v[168:171]
  ds_read_b128 v[132:135], v33 offset:20480
  s_waitcnt lgkmcnt(6)
  v_mfma_f32_16x16x32_bf16 v[172:175], a[200:203], v[140:143], v[172:175]
  ds_read_b128 v[136:139], v34 offset:20480
  s_waitcnt lgkmcnt(6)
  v_mfma_f32_16x16x32_bf16 v[160:163], a[204:207], v[144:147], v[160:163]
  ds_read_b128 v[140:143], v35 offset:20480
  s_waitcnt lgkmcnt(6)
  v_mfma_f32_16x16x32_bf16 v[164:167], a[204:207], v[148:151], v[164:167]
  ds_read_b128 v[144:147], v32 offset:21504
  s_waitcnt lgkmcnt(6)
  v_mfma_f32_16x16x32_bf16 v[168:171], a[204:207], v[152:155], v[168:171]
  ds_read_b128 v[148:151], v33 offset:21504
  s_waitcnt lgkmcnt(6)
  v_mfma_f32_16x16x32_bf16 v[172:175], a[204:207], v[156:159], v[172:175]
  ds_read_b128 v[152:155], v34 offset:21504
  s_waitcnt lgkmcnt(6)
  v_mfma_f32_16x16x32_bf16 v[160:163], a[208:211], v[128:131], v[160:163]
  ds_read_b128 v[156:159], v35 offset:21504
  s_waitcnt lgkmcnt(6)
  v_mfma_f32_16x16x32_bf16 v[164:167], a[208:211], v[132:135], v[164:167]
  ds_read_b128 v[128:131], v32 offset:22528
  s_waitcnt lgkmcnt(6)
  v_mfma_f32_16x16x32_bf16 v[168:171], a[208:211], v[136:139], v[168:171]
  ds_read_b128 v[132:135], v33 offset:22528
  s_waitcnt lgkmcnt(6)
  v_mfma_f32_16x16x32_bf16 v[172:175], a[208:211], v[140:143], v[172:175]
  ds_read_b128 v[136:139], v34 offset:22528
  s_waitcnt lgkmcnt(6)
  v_mfma_f32_16x16x32_bf16 v[160:163], a[212:215], v[144:147], v[160:163]
  ds_read_b128 v[140:143], v35 offset:22528
  s_waitcnt lgkmcnt(6)
  v_mfma_f32_16x16x32_bf16 v[164:167], a[212:215], v[148:151], v[164:167]
  ds_read_b128 v[144:147], v32 offset:23552
  s_waitcnt lgkmcnt(6)
  v_mfma_f32_16x16x32_bf16 v[168:171], a[212:215], v[152:155], v[168:171]
  ds_read_b128 v[148:151], v33 offset:23552
  s_waitcnt lgkmcnt(6)
  v_mfma_f32_16x16x32_bf16 v[172:175], a[212:215], v[156:159], v[172:175]
  ds_read_b128 v[152:155], v34 offset:23552
  s_waitcnt lgkmcnt(6)
  v_mfma_f32_16x16x32_bf16 v[160:163], a[216:219], v[128:131], v[160:163]
  ds_read_b128 v[156:159], v35 offset:23552
  s_waitcnt lgkmcnt(6)
  v_mfma_f32_16x16x32_bf16 v[164:167], a[216:219], v[132:135], v[164:167]
  s_waitcnt lgkmcnt(5)
  v_mfma_f32_16x16x32_bf16 v[168:171], a[216:219], v[136:139], v[168:171]
  s_waitcnt lgkmcnt(4)
  v_mfma_f32_16x16x32_bf16 v[172:175], a[216:219], v[140:143], v[172:175]
  s_waitcnt lgkmcnt(3)
  v_mfma_f32_16x16x32_bf16 v[160:163], a[220:223], v[144:147], v[160:163]
  s_waitcnt lgkmcnt(2)
  v_mfma_f32_16x16x32_bf16 v[164:167], a[220:223], v[148:151], v[164:167]
  s_waitcnt lgkmcnt(1)
  v_mfma_f32_16x16x32_bf16 v[168:171], a[220:223], v[152:155], v[168:171]
  s_waitcnt lgkmcnt(0)
  v_mfma_f32_16x16x32_bf16 v[172:175], a[220:223], v[156:159], v[172:175]
  s_waitcnt vmcnt(0)
  s_barrier
  ds_read_b128 v[128:131], v32 offset:8192
  ds_read_b128 v[132:135], v33 offset:8192
  ds_read_b128 v[136:139], v34 offset:8192
  ds_read_b128 v[140:143], v35 offset:8192
  ds_read_b128 v[144:147], v32 offset:9216
  ds_read_b128 v[148:151], v33 offset:9216
  ds_read_b128 v[152:155], v34 offset:9216
  s_waitcnt lgkmcnt(6)
  v_mfma_f32_16x16x32_bf16 v[160:163], a[224:227], v[128:131], v[160:163]
  ds_read_b128 v[156:159], v35 offset:9216
  s_waitcnt lgkmcnt(6)
  v_mfma_f32_16x16x32_bf16 v[164:167], a[224:227], v[132:135], v[164:167]
  ds_read_b128 v[128:131], v32 offset:10240
  s_waitcnt lgkmcnt(6)
  v_mfma_f32_16x16x32_bf16 v[168:171], a[224:227], v[136:139], v[168:171]
  ds_read_b128 v[132:135], v33 offset:10240
  s_waitcnt lgkmcnt(6)
  v_mfma_f32_16x16x32_bf16 v[172:175], a[224:227], v[140:143], v[172:175]
  ds_read_b128 v[136:139], v34 offset:10240
  s_waitcnt lgkmcnt(6)
  v_mfma_f32_16x16x32_bf16 v[160:163], a[228:231], v[144:147], v[160:163]
  ds_read_b128 v[140:143], v35 offset:10240
  s_waitcnt lgkmcnt(6)
  v_mfma_f32_16x16x32_bf16 v[164:167], a[228:231], v[148:151], v[164:167]
  ds_read_b128 v[144:147], v32 offset:11264
  s_waitcnt lgkmcnt(6)
  v_mfma_f32_16x16x32_bf16 v[168:171], a[228:231], v[152:155], v[168:171]
  ds_read_b128 v[148:151], v33 offset:11264
  s_waitcnt lgkmcnt(6)
  v_mfma_f32_16x16x32_bf16 v[172:175], a[228:231], v[156:159], v[172:175]
  ds_read_b128 v[152:155], v34 offset:11264
  s_waitcnt lgkmcnt(6)
  v_mfma_f32_16x16x32_bf16 v[160:163], a[232:235], v[128:131], v[160:163]
  ds_read_b128 v[156:159], v35 offset:11264
  s_waitcnt lgkmcnt(6)
  v_mfma_f32_16x16x32_bf16 v[164:167], a[232:235], v[132:135], v[164:167]
  ds_read_b128 v[128:131], v32 offset:12288
  s_waitcnt lgkmcnt(6)
  v_mfma_f32_16x16x32_bf16 v[168:171], a[232:235], v[136:139], v[168:171]
  ds_read_b128 v[132:135], v33 offset:12288
  s_waitcnt lgkmcnt(6)
  v_mfma_f32_16x16x32_bf16 v[172:175], a[232:235], v[140:143], v[172:175]
  ds_read_b128 v[136:139], v34 offset:12288
  s_waitcnt lgkmcnt(6)
  v_mfma_f32_16x16x32_bf16 v[160:163], a[236:239], v[144:147], v[160:163]
  ds_read_b128 v[140:143], v35 offset:12288
  s_waitcnt lgkmcnt(6)
  v_mfma_f32_16x16x32_bf16 v[164:167], a[236:239], v[148:151], v[164:167]
  ds_read_b128 v[144:147], v32 offset:13312
  s_waitcnt lgkmcnt(6)
  v_mfma_f32_16x16x32_bf16 v[168:171], a[236:239], v[152:155], v[168:171]
  ds_read_b128 v[148:151], v33 offset:13312
  s_waitcnt lgkmcnt(6)
  v_mfma_f32_16x16x32_bf16 v[172:175], a[236:239], v[156:159], v[172:175]
  ds_read_b128 v[152:155], v34 offset:13312
  s_waitcnt lgkmcnt(6)
  v_mfma_f32_16x16x32_bf16 v[160:163], a[240:243], v[128:131], v[160:163]
  ds_read_b128 v[156:159], v35 offset:13312
  s_waitcnt lgkmcnt(6)
  v_mfma_f32_16x16x32_bf16 v[164:167], a[240:243], v[132:135], v[164:167]
  ds_read_b128 v[128:131], v32 offset:14336
  s_waitcnt lgkmcnt(6)
  v_mfma_f32_16x16x32_bf16 v[168:171], a[240:243], v[136:139], v[168:171]
  ds_read_b128 v[132:135], v33 offset:14336
  s_waitcnt lgkmcnt(6)
  v_mfma_f32_16x16x32_bf16 v[172:175], a[240:243], v[140:143], v[172:175]
  ds_read_b128 v[136:139], v34 offset:14336
  s_waitcnt lgkmcnt(6)
  v_mfma_f32_16x16x32_bf16 v[160:163], a[244:247], v[144:147], v[160:163]
  ds_read_b128 v[140:143], v35 offset:14336
  s_waitcnt lgkmcnt(6)
  v_mfma_f32_16x16x32_bf16 v[164:167], a[244:247], v[148:151], v[164:167]
  ds_read_b128 v[144:147], v32 offset:15360
  s_waitcnt lgkmcnt(6)
  v_mfma_f32_16x16x32_bf16 v[168:171], a[244:247], v[152:155], v[168:171]
  ds_read_b128 v[148:151], v33 offset:15360
  s_waitcnt lgkmcnt(6)
  v_mfma_f32_16x16x32_bf16 v[172:175], a[244:247], v[156:159], v[172:175]
  ds_read_b128 v[152:155], v34 offset:15360
  s_waitcnt lgkmcnt(6)
  v_mfma_f32_16x16x32_bf16 v[160:163], a[248:251], v[128:131], v[160:163]
  ds_read_b128 v[156:159], v35 offset:15360
  s_waitcnt lgkmcnt(6)
  v_mfma_f32_16x16x32_bf16 v[164:167], a[248:251], v[132:135], v[164:167]
  s_waitcnt lgkmcnt(5)
  v_mfma_f32_16x16x32_bf16 v[168:171], a[248:251], v[136:139], v[168:171]
  s_waitcnt lgkmcnt(4)
  v_mfma_f32_16x16x32_bf16 v[172:175], a[248:251], v[140:143], v[172:175]
  s_waitcnt lgkmcnt(3)
  v_mfma_f32_16x16x32_bf16 v[160:163], a[252:255], v[144:147], v[160:163]
  s_waitcnt lgkmcnt(2)
  v_mfma_f32_16x16x32_bf16 v[164:167], a[252:255], v[148:151], v[164:167]
  s_waitcnt lgkmcnt(1)
  v_mfma_f32_16x16x32_bf16 v[168:171], a[252:255], v[152:155], v[168:171]
  s_waitcnt lgkmcnt(0)
  v_mfma_f32_16x16x32_bf16 v[172:175], a[252:255], v[156:159], v[172:175]
  s_lshl_b32 s22, s46, 10
  v_add_u32 v220, s22, v12
  v_add_f32 v160, v216, v160
  v_add_f32 v161, v216, v161
  v_add_f32 v162, v216, v162
  v_add_f32 v163, v216, v163
  v_cvt_pk_bf16_f32 v224, v160, v161
  v_cvt_pk_bf16_f32 v225, v162, v163
  global_store_dwordx2 v220, v[224:225], s[8:9]
  s_lshl_b32 s22, s47, 10
  v_add_u32 v221, s22, v12
  v_add_f32 v164, v217, v164
  v_add_f32 v165, v217, v165
  v_add_f32 v166, v217, v166
  v_add_f32 v167, v217, v167
  v_cvt_pk_bf16_f32 v226, v164, v165
  v_cvt_pk_bf16_f32 v227, v166, v167
  global_store_dwordx2 v221, v[226:227], s[8:9]
  s_lshl_b32 s22, s48, 10
  v_add_u32 v222, s22, v12
  v_add_f32 v168, v218, v168
  v_add_f32 v169, v218, v169
  v_add_f32 v170, v218, v170
  v_add_f32 v171, v218, v171
  v_cvt_pk_bf16_f32 v228, v168, v169
  v_cvt_pk_bf16_f32 v229, v170, v171
  global_store_dwordx2 v222, v[228:229], s[8:9]
  s_lshl_b32 s22, s49, 10
  v_add_u32 v223, s22, v12
  v_add_f32 v172, v219, v172
  v_add_f32 v173, v219, v173
  v_add_f32 v174, v219, v174
  v_add_f32 v175, v219, v175
  v_cvt_pk_bf16_f32 v230, v172, v173
  v_cvt_pk_bf16_f32 v231, v174, v175
  global_store_dwordx2 v223, v[230:231], s[8:9]
K2_done:
  s_endpgm
.section .rodata,"a"
.p2align 6

.amdhsa_kernel k1_kernel
  .amdhsa_next_free_vgpr 256
  .amdhsa_next_free_sgpr 102
  .amdhsa_accum_offset 256
  .amdhsa_group_segment_fixed_size 0
  .amdhsa_kernarg_size 96
  .amdhsa_user_sgpr_count 2
  .amdhsa_user_sgpr_kernarg_segment_ptr 1
  .amdhsa_system_sgpr_workgroup_id_x 1
.end_amdhsa_kernel

.p2align 6

.amdhsa_kernel k2_kernel
  .amdhsa_next_free_vgpr 512
  .amdhsa_next_free_sgpr 102
  .amdhsa_accum_offset 256
  .amdhsa_group_segment_fixed_size 0
  .amdhsa_kernarg_size 96
  .amdhsa_user_sgpr_count 2
  .amdhsa_user_sgpr_kernarg_segment_ptr 1
  .amdhsa_system_sgpr_workgroup_id_x 1
.end_amdhsa_kernel
```
